```python
import torch

def _softmax(x, axis=-1):
    return torch.softmax(x, dim=axis)
def _gelu(x):
    return torch.nn.functional.gelu(x, approximate="tanh")
def _silu(x):
    return torch.nn.functional.silu(x)
def _sigmoid(x):
    return torch.sigmoid(x)
def _layernorm(x, axis=-1, eps=1e-5):
    m = x.mean(dim=axis, keepdim=True)
    v = x.var(dim=axis, keepdim=True, unbiased=False)
    return (x - m) / torch.sqrt(v + eps)
def _scatter_add(tgt, idx, src, axis=0):
    return tgt.clone().index_add_(axis, idx, src)
def _segment_sum(src, seg, n):
    out = torch.zeros((n,) + src.shape[1:], dtype=src.dtype)
    return out.index_add_(0, seg, src)
def _pad(x, pw):
    flat = tuple(v for pair in reversed(pw) for v in pair)
    return torch.nn.functional.pad(x, flat)

kernel_name = 'gated_mix__softmax_full_mha__mha_block__prompt'

def setup_inputs():

    _w = (lambda a: (lambda t: t.to(torch.bfloat16) if t.is_floating_point() else t)(torch.as_tensor(a)))
    def _A_setup():
        B, S, D = 1, 2048, 448
        return {
            "x": _w((lambda *s: torch.randn(*s, dtype=torch.bfloat16) * 0.05)(B, S, D)),
            "wqkv": _w((lambda *s: torch.randn(*s, dtype=torch.bfloat16) * 0.8)(D, 3 * D)),
            "wo": _w((lambda *s: torch.randn(*s, dtype=torch.bfloat16) * 0.05)(D, D)),
        }
    _A_in = _A_setup()

    def _B_setup():
        B, S, D, H = 1, 2048, 448, 16
        return {
            "x": _w((lambda *s: torch.randn(*s, dtype=torch.bfloat16) * 0.05)(B, S, D)),
            "wqkv": _w((lambda *s: torch.randn(*s, dtype=torch.bfloat16) * 0.8)(D, 3 * D)),
            "wo": _w((lambda *s: torch.randn(*s, dtype=torch.bfloat16) * 0.05)(D, D)),
        }
    _B_in = _B_setup()

    return {
        "A_x": _A_in["x"],
        "A_wqkv": _A_in["wqkv"],
        "A_wo": _A_in["wo"],
        "B_x": _B_in["x"],
        "B_wqkv": _B_in["wqkv"],
        "B_wo": _B_in["wo"],
        "gate_w": _w((lambda *s: torch.randn(*s, dtype=torch.bfloat16) * 0.05)(448) * 16.0),
    }

def reference(A_x, A_wqkv, A_wo, B_x, B_wqkv, B_wo, gate_w):
    def _A_ref(x, wqkv, wo):
        B, S, D = x.shape
        H = 16; Dh = D // H
        qkv = (lambda x, *d: x.permute(*d))((x @ wqkv).reshape(B, S, 3, H, Dh), 2, 0, 3, 1, 4)
        q, k, v = qkv[0], qkv[1], qkv[2]
        scale = Dh ** -0.5
        scores = torch.einsum("bhqd,bhkd->bhqk", q, k) * scale
        p = _softmax(scores, axis=-1)
        o = torch.einsum("bhqk,bhkd->bhqd", p, v)
        return (lambda x, *d: x.permute(*d))(o, 0, 2, 1, 3).reshape(B, S, D) @ wo

    def _B_ref(x, wqkv, wo):
        B, S, D = x.shape
        H = 16
        Dh = D // H
        qkv = (lambda x, *d: x.permute(*d))((x @ wqkv).reshape(B, S, 3, H, Dh), 2, 0, 3, 1, 4)
        q, k, v = qkv[0], qkv[1], qkv[2]
        scores = torch.einsum("bhqd,bhkd->bhqk", q, k) * (Dh ** -0.5)
        p = _softmax(scores, axis=-1)
        o = torch.einsum("bhqk,bhkd->bhqd", p, v)
        return (lambda x, *d: x.permute(*d))(o, 0, 2, 1, 3).reshape(B, S, D) @ wo

    x = A_x
    g = _sigmoid((x * gate_w).sum(-1, keepdims=True))
    a = _A_ref(x, A_wqkv, A_wo)
    b = _B_ref(x, B_wqkv, B_wo)
    return g * a + (1 - g) * b
```

```asm
; @launch kernel=fused_kernel grid=(256,1,1) block=(512,1,1) lds=163840
.amdgcn_target "amdgcn-amd-amdhsa--gfx950"
.text
.globl fused_kernel
.p2align 8
.type fused_kernel,@function
fused_kernel:
    s_cmp_ge_u32 s2, 256
    s_cbranch_scc1 Lend
    s_load_dwordx16 s[36:51], s[0:1], 0
    s_load_dwordx4 s[52:55], s[0:1], 64
    s_memrealtime s[98:99]
    v_lshrrev_b32 v3, 6, v0
    v_and_b32 v2, 63, v0
    s_and_b32 s57, s2, 7
    v_readfirstlane_b32 s56, v3
    s_lshl_b32 s57, s57, 2
    s_lshr_b32 s64, s2, 6
    s_add_u32 s57, s57, s64
    s_bfe_u32 s58, s2, 0x30003
    v_lshrrev_b32 v3, 3, v2
    v_lshrrev_b32 v5, 4, v2
    v_xor_b32 v5, v5, v2
    v_and_b32 v5, 7, v5
    v_mul_u32_u24 v3, 896, v3
    v_lshl_add_u32 v8, v5, 4, v3
    v_xor_b32 v5, 64, v8
    v_add_u32 v9, 6144, v5
    v_add_u32 v10, 12288, v8
    v_add_u32 v11, 18432, v5
    v_lshrrev_b32 v3, 2, v2
    v_mul_u32_u24 v3, 2688, v3
    v_and_b32 v5, 3, v2
    v_lshlrev_b32 v5, 4, v5
    v_min_u32 v5, 40, v5
    v_add_u32 v12, v3, v5
    s_lshl_b32 s59, s57, 1
    s_add_u32 s59, s59, s58
    s_bitcmp1_b32 s57, 0
    s_mov_b32 s70, 0xd090402
    s_cselect_b32 s70, 0xc0b0600, s70
    s_mov_b32 s71, 0x1d191412
    s_cselect_b32 s71, 0x1c1b1610, s71
    s_mov_b32 s72, 0xe080501
    s_cselect_b32 s72, 0xf0a0703, s72
    s_mov_b32 s73, 0x1e181511
    s_cselect_b32 s73, 0x1f1a1713, s73
    s_bitcmp1_b32 s57, 1
    s_cselect_b64 s[70:71], s[72:73], s[70:71]
    s_lshr_b32 s64, s57, 2
    s_lshl_b32 s64, s64, 3
    s_lshr_b64 s[70:71], s[70:71], s64
    s_and_b32 s57, s70, 31
    s_mul_i32 s64, s59, 147
    s_lshr_b32 s64, s64, 10
    s_mul_i32 s64, s64, 7
    s_sub_u32 s59, s59, s64
    s_mov_b32 s24, s59
    s_lshl_b32 s60, s58, 3
    s_add_u32 s60, s60, s56
    s_lshl_b32 s68, s60, 12
    s_mul_i32 s60, s60, 28672
    s_lshl_b32 s62, s56, 12
    s_and_b32 s66, s57, 15
    s_mul_i32 s66, s66, 56
    s_lshr_b32 s64, s56, 2
    s_and_b32 s65, s56, 3
    s_mul_i32 s69, s65, 43008
    s_add_u32 s69, s69, s66
    s_mul_i32 s61, s64, 896
    s_add_u32 s61, s61, s69
    s_add_u32 s61, s61, 896
    s_mul_i32 s63, s64, 28672
    s_lshl_b32 s65, s65, 10
    s_add_u32 s63, s63, s65
    s_mul_i32 s67, s64, 6
    s_add_u32 s67, s67, s59
    s_mov_b32 s6, 1835008
    s_mov_b32 s7, 0x00020000
    s_mov_b32 s10, 1204224
    s_mov_b32 s11, 0x00020000
    s_cmp_ge_u32 s57, 16
    s_waitcnt lgkmcnt(0)
    s_mov_b32 s4, s36
    s_mov_b32 s5, s37
    s_cselect_b32 s8, s44, s38
    s_cselect_b32 s9, s45, s39
    s_add_u32 m0, s63, 65536
    s_mul_i32 s65, s24, 172032
    s_add_u32 s65, s65, s61
    buffer_load_dwordx4 v12, s[8:11], s65 offen   lds
    s_add_u32 s24, s24, 1
    s_cmp_eq_u32 s24, 7
    s_cselect_b32 s24, 0, s24
    s_lshl_b32 s66, s59, 7
    s_add_u32 m0, s62, 0
    s_add_u32 s66, s66, s60
    buffer_load_dwordx4 v8, s[4:7], s66 offen offset:0   lds
    buffer_load_dwordx4 v9, s[4:7], s66 offen offset:1024   lds
    buffer_load_dwordx4 v10, s[4:7], s66 offen offset:2048   lds
    buffer_load_dwordx4 v11, s[4:7], s66 offen offset:3072   lds
    s_add_u32 s59, s59, 1
    s_cmp_eq_u32 s59, 7
    s_cselect_b32 s59, 0, s59
    s_mov_b32 s32, s52
    s_mov_b32 s33, s53
    s_mov_b32 s34, 256
    s_mov_b32 s35, 0x00020000
    v_mov_b32 v6, 0
    s_or_b32 s64, s56, s2
    s_cbranch_scc1 Lnononce
    v_mov_b32 v126, s98
    v_mov_b32 v127, s99
    v_or_b32 v126, 1, v126
    s_mov_b64 exec, 1
    buffer_store_dwordx2 v[126:127], v6, s[32:35], 0 offen sc1
    s_mov_b64 exec, -1
Lnononce:
    s_mov_b32 s12, s54
    s_mov_b32 s13, s55
    s_mov_b32 s14, 20971520
    s_mov_b32 s15, 0x00020000
    s_mov_b32 s16, s48
    s_mov_b32 s17, s49
    s_mov_b32 s18, 896
    s_mov_b32 s19, 0x00020000
    s_mov_b32 s28, s50
    s_mov_b32 s29, s51
    s_mov_b32 s30, 1835008
    s_mov_b32 s31, 0x00020000
    s_cmp_ge_u32 s56, 4
    s_cselect_b32 s20, s46, s40
    s_cselect_b32 s21, s47, s41
    s_cselect_b32 s64, 0, -1
    s_mov_b32 s22, 401408
    s_mov_b32 s23, 0x00020000
    v_and_b32 v20, s64, v12
    s_cmp_ge_u32 s67, 7
    s_cselect_b32 s64, 7, 0
    s_sub_u32 s39, s67, s64
    v_lshrrev_b32 v3, 4, v2
    v_lshl_add_u32 v5, v3, 1, s39
    v_subrev_u32 v24, 7, v5
    v_min_u32 v5, v5, v24
    v_and_b32 v24, 15, v2
    v_lshlrev_b32 v15, 1, v24
    v_lshl_add_u32 v15, v5, 7, v15
    s_and_b32 s64, s56, 3
    s_lshl_b32 s64, s64, 5
    buffer_load_ushort v122, v15, s[16:19], s64 offen
    v_lshlrev_b32 v24, 6, v24
    v_lshl_add_u32 v24, v3, 13, v24
    s_lshl_b32 s53, s64, 5
    s_and_b32 s64, s56, 4
    s_lshl_b32 s64, s64, 10
    s_sub_u32 s53, s53, s64
    v_add_u32 v24, s53, v24
    v_and_b32 v24, 0x7fff, v24
    v_add_u32 v21, 131120, v24
    s_add_u32 s64, s59, 6
    s_cmp_ge_u32 s64, 7
    s_cselect_b32 s65, 7, 0
    s_sub_u32 s64, s64, s65
    v_and_b32 v3, 7, v2
    v_add_u32 v3, s64, v3
    v_subrev_u32 v5, 7, v3
    v_min_u32 v3, v3, v5
    s_lshl_b32 s65, s57, 10
    s_add_u32 s65, s65, 14680064
    v_lshl_add_u32 v117, v3, 7, s65
    v_mov_b32 v118, 0
    v_mov_b32 v119, 0
    s_lshl_b32 s25, s57, 7
    s_add_u32 s25, s25, s56
    s_lshl_b32 s25, s25, 10
    s_add_u32 s25, s25, 16777216
    s_lshl_b32 s27, s64, 14
    s_add_u32 s27, s27, s25
    s_lshl_b32 s43, s68, 4
    s_lshl_b32 s64, s57, 11
    s_add_u32 s43, s43, s64
    s_add_u32 s43, s43, 8388608
    s_lshr_b32 s44, s68, 3
    s_lshr_b32 s65, s57, 3
    s_lshl_b32 s65, s65, 7
    s_add_u32 s44, s44, s65
    s_and_b32 s65, s57, 7
    s_lshl_b32 s65, s65, 3
    s_add_u32 s44, s44, s65
    s_add_u32 s44, s44, 12648448
    s_lshl_b32 s47, s57, 18
    s_add_u32 s68, s68, s47
    s_mov_b32 s42, 0xfe
    s_lshl_b32 s38, s57, 3
    s_add_u32 s38, s38, s56
    s_lshl_b32 s38, s38, 10
    s_add_u32 s38, s38, 13631488
    s_mov_b32 s76, 0x3e8b97f6
    s_mov_b32 s77, 0x3e8b97f6
    s_cmp_ge_u32 s57, 16
    s_cselect_b32 s40, -1.0, 1.0
    s_cselect_b32 s41, 1.0, 0
    s_and_b32 s36, s2, 7
    s_lshl_b32 s36, s36, 2
    s_lshr_b32 s3, s2, 5
    s_lshr_b32 s64, s2, 3
    s_add_u32 s64, s64, s3
    s_and_b32 s64, s64, 3
    s_add_u32 s36, s36, s64
    s_bfe_u32 s64, s56, 0x10001
    s_mul_i32 s79, s64, 200704
    s_and_b32 s64, s56, 1
    s_mul_i32 s64, s64, 50176
    s_add_u32 s79, s79, s64
    s_min_u32 s64, s3, 6
    s_lshl_b32 s64, s64, 7
    s_add_u32 s79, s79, s64
    s_lshr_b32 s64, s56, 2
    s_and_b32 s65, s56, 3
    s_lshl_b32 s37, s64, 15
    s_mul_i32 s67, s65, 7168
    s_add_u32 s37, s37, s67
    s_add_u32 s37, s37, 98304
    s_lshl_b32 s67, s36, 3
    s_add_u32 s67, s67, s56
    s_lshl_b32 s45, s67, 7
    s_add_u32 s45, s45, 12648448
    s_lshl_b32 s46, s67, 14
    s_add_u32 s46, s46, 8388608
    s_lshr_b32 s64, s65, 1
    s_lshl_b32 s64, s64, 15
    s_and_b32 s65, s65, 1
    s_mul_i32 s65, s65, 14336
    s_add_u32 s64, s64, s65
    s_add_u32 s64, s64, 98304
    v_bfe_u32 v3, v2, 2, 2
    v_bfe_u32 v5, v2, 4, 1
    v_lshlrev_b32 v5, 5, v5
    v_lshl_add_u32 v3, v3, 6, v5
    v_and_b32 v5, 3, v2
    v_lshl_add_u32 v3, v5, 3, v3
    v_add_u32 v3, s64, v3
    v_lshrrev_b32 v5, 5, v2
    v_lshl_add_u32 v0, v5, 8, v3
    v_mul_u32_u24 v5, 768, v5
    v_add_u32 v125, v5, v3
    v_bfe_u32 v3, v2, 2, 3
    v_mul_u32_u24 v3, 896, v3
    v_lshrrev_b32 v5, 5, v2
    v_lshl_add_u32 v3, v5, 6, v3
    v_and_b32 v5, 3, v2
    v_lshl_add_u32 v124, v5, 4, v3
    v_lshlrev_b32 v1, 4, v2
    v_and_b32 v3, 31, v2
    v_lshrrev_b32 v24, 5, v2
    v_bfe_u32 v25, v2, 1, 3
    v_xor_b32 v25, v25, v24
    v_lshlrev_b32 v25, 4, v25
    v_lshl_add_u32 v25, v3, 7, v25
    v_add_u32 v16, s62, v25
    v_xor_b32 v17, 32, v16
    v_xor_b32 v18, 64, v16
    v_xor_b32 v19, 96, v16
    v_bfe_u32 v25, v2, 2, 2
    v_lshl_add_u32 v25, v24, 3, v25
    v_bfe_u32 v26, v2, 4, 1
    v_lshlrev_b32 v26, 5, v26
    v_lshl_add_u32 v25, v25, 6, v26
    v_and_b32 v26, 3, v2
    v_lshl_add_u32 v25, v26, 3, v25
    v_add_u32 v13, 65536, v25
    v_add_u32 v14, 131072, v25
    v_cmp_gt_u32 s[70:71], 32, v2
    v_cmp_eq_u32 s[72:73], 24, v3
    v_lshrrev_b32 v29, 2, v3
    s_lshr_b32 s64, s56, 2
    s_lshl_b32 s64, s64, 14
    v_add_u32 v120, s64, v1
    v_add_u32 v121, 65536, v120
    v_add_u32 v3, s58, v2
    v_and_b32 v3, 7, v3
    v_lshlrev_b32 v123, 7, v3
    v_and_b32 v3, 7, v2
    v_lshlrev_b32 v3, 11, v3
    v_mov_b32 v24, 0x3f80
    v_mov_b32 v25, 0x3f803f80
    v_cndmask_b32 v25, 0, v25, s[72:73]
    v_cmp_eq_u32 s[72:73], 6, v29
    v_add_u32 v26, s62, v1
    v_lshrrev_b32 v22, 1, v1
    v_xor_b32 v22, v22, v1
    v_and_b32 v22, 64, v22
    v_mul_u32_u24 v22, 3, v22
    v_xor_b32 v22, v22, v1
    v_add_u32 v23, s62, v22
    v_mov_b32 v31, 0xdddddddd
    s_lshr_b32 s64, s62, 1
    s_add_u32 s64, s64, 98304
    s_xor_b32 s65, s64, 8192
    s_add_u32 s52, s62, 32768
    v_mov_b32 v4, 0
    v_mov_b32 v5, 0
    v_add_u32 v28, s64, v1
    v_add_u32 v27, s65, v1
    s_add_u32 m0, s63, 69632
    s_mul_i32 s65, s24, 172032
    s_add_u32 s65, s65, s61
    buffer_load_dwordx4 v12, s[8:11], s65 offen   lds
    s_add_u32 s24, s24, 1
    s_cmp_eq_u32 s24, 7
    s_cselect_b32 s24, 0, s24
    s_lshl_b32 s66, s59, 7
    s_add_u32 m0, s62, 32768
    s_add_u32 s66, s66, s60
    buffer_load_dwordx4 v8, s[4:7], s66 offen offset:0   lds
    buffer_load_dwordx4 v9, s[4:7], s66 offen offset:1024   lds
    buffer_load_dwordx4 v10, s[4:7], s66 offen offset:2048   lds
    buffer_load_dwordx4 v11, s[4:7], s66 offen offset:3072   lds
    s_add_u32 s59, s59, 1
    s_cmp_eq_u32 s59, 7
    s_cselect_b32 s59, 0, s59
    s_getpc_b64 s[54:55]
Lpc:
    s_lshr_b32 s64, s2, 3
    s_mul_i32 s64, s64, 768
    v_min_u32 v29, 5, v2
    v_lshlrev_b32 v29, 7, v29
    v_add_u32 v29, s64, v29
    v_min_u32 v29, Lcode_end-Lpc-4, v29
    global_load_dword v30, v29, s[54:55]
    v_add_u32 v117, s53, v1
    v_add_u32 v117, 131072, v117
    v_mov_b64 v[112:113], -1
    v_mov_b64 v[114:115], -1
    ds_write_b128 v117, v[112:115] offset:16384
    ds_write_b128 v117, v[112:115] offset:24576
    s_waitcnt vmcnt(7)
    s_barrier
    ds_read_b128 v[128:131], v16 offset:0
    ds_read_b64_tr_b16 v[80:81], v13 offset:0
    ds_read_b64_tr_b16 v[82:83], v13 offset:256
    ds_read_b64_tr_b16 v[84:85], v13 offset:28672
    ds_read_b64_tr_b16 v[86:87], v13 offset:28928
    ds_read_b64_tr_b16 v[88:89], v13 offset:1024
    ds_read_b64_tr_b16 v[90:91], v13 offset:1280
    ds_read_b64_tr_b16 v[92:93], v13 offset:29696
    ds_read_b64_tr_b16 v[94:95], v13 offset:29952
    ds_read_b64_tr_b16 v[240:241], v13 offset:2048
    ds_read_b64_tr_b16 v[242:243], v13 offset:2304
    ds_read_b128 v[132:135], v17 offset:0
    ds_read_b128 v[136:139], v18 offset:0
    ds_read_b128 v[140:143], v19 offset:0
    s_waitcnt lgkmcnt(13)
    s_waitcnt lgkmcnt(11)
    v_mfma_f32_32x32x16_bf16 v[32:47], v[80:83], v[128:131], 0
    ds_read_b64_tr_b16 v[244:245], v13 offset:30720
    ds_read_b64_tr_b16 v[246:247], v13 offset:30976
    s_add_u32 m0, s63, 73728
    s_mul_i32 s65, s24, 172032
    s_add_u32 s65, s65, s61
    buffer_load_dwordx4 v12, s[8:11], s65 offen   lds
    s_add_u32 s24, s24, 1
    s_cmp_eq_u32 s24, 7
    s_cselect_b32 s24, 0, s24
    s_waitcnt lgkmcnt(11)
    v_mfma_f32_32x32x16_bf16 v[48:63], v[128:131], v[84:87], 0
    ds_read_b64_tr_b16 v[248:249], v13 offset:3072
    ds_read_b64_tr_b16 v[250:251], v13 offset:3328
    s_waitcnt lgkmcnt(4)
    s_lshl_b32 s66, s59, 7
    s_add_u32 m0, s62, 0
    s_add_u32 s66, s66, s60
    buffer_load_dwordx4 v8, s[4:7], s66 offen offset:0   lds
    v_mfma_f32_32x32x16_bf16 v[32:47], v[88:91], v[132:135], v[32:47]
    ds_read_b64_tr_b16 v[252:253], v13 offset:31744
    ds_read_b64_tr_b16 v[254:255], v13 offset:32000
    buffer_load_dwordx4 v9, s[4:7], s66 offen offset:1024   lds
    v_mfma_f32_32x32x16_bf16 v[48:63], v[132:135], v[92:95], v[48:63]
    buffer_load_dwordx4 v10, s[4:7], s66 offen offset:2048   lds
    v_mfma_f32_32x32x16_bf16 v[32:47], v[240:243], v[136:139], v[32:47]
    buffer_load_dwordx4 v11, s[4:7], s66 offen offset:3072   lds
    s_add_u32 s59, s59, 1
    s_cmp_eq_u32 s59, 7
    s_cselect_b32 s59, 0, s59
    s_waitcnt lgkmcnt(4)
    v_mfma_f32_32x32x16_bf16 v[48:63], v[136:139], v[244:247], v[48:63]
    s_waitcnt vmcnt(6)
    s_barrier
    ds_read_b128 v[144:147], v16 offset:32768
    ds_read_b64_tr_b16 v[80:81], v13 offset:4096
    ds_read_b64_tr_b16 v[82:83], v13 offset:4352
    ds_read_b64_tr_b16 v[84:85], v13 offset:32768
    ds_read_b64_tr_b16 v[86:87], v13 offset:33024
    ds_read_b64_tr_b16 v[88:89], v13 offset:5120
    ds_read_b64_tr_b16 v[90:91], v13 offset:5376
    ds_read_b128 v[148:151], v17 offset:32768
    ds_read_b128 v[152:155], v18 offset:32768
    ds_read_b128 v[156:159], v19 offset:32768
    s_add_u32 m0, s63, 77824
    s_mul_i32 s65, s24, 172032
    s_add_u32 s65, s65, s61
    buffer_load_dwordx4 v12, s[8:11], s65 offen   lds
    s_add_u32 s24, s24, 1
    s_cmp_eq_u32 s24, 7
    s_cselect_b32 s24, 0, s24
    s_waitcnt lgkmcnt(12)
    v_mfma_f32_32x32x16_bf16 v[32:47], v[248:251], v[140:143], v[32:47]
    ds_read_b64_tr_b16 v[92:93], v13 offset:33792
    ds_read_b64_tr_b16 v[94:95], v13 offset:34048
    s_waitcnt lgkmcnt(12)
    v_mfma_f32_32x32x16_bf16 v[48:63], v[140:143], v[252:255], v[48:63]
    ds_read_b64_tr_b16 v[240:241], v13 offset:6144
    ds_read_b64_tr_b16 v[242:243], v13 offset:6400
    s_waitcnt lgkmcnt(13)
    s_waitcnt lgkmcnt(11)
    v_mfma_f32_32x32x16_bf16 v[32:47], v[80:83], v[144:147], v[32:47]
    ds_read_b64_tr_b16 v[244:245], v13 offset:34816
    ds_read_b64_tr_b16 v[246:247], v13 offset:35072
    s_waitcnt lgkmcnt(11)
    v_mfma_f32_32x32x16_bf16 v[48:63], v[144:147], v[84:87], v[48:63]
    ds_read_b64_tr_b16 v[248:249], v13 offset:7168
    ds_read_b64_tr_b16 v[250:251], v13 offset:7424
    s_waitcnt lgkmcnt(8)
    s_lshl_b32 s66, s59, 7
    s_add_u32 m0, s62, 32768
    s_add_u32 s66, s66, s60
    buffer_load_dwordx4 v8, s[4:7], s66 offen offset:0   lds
    v_mfma_f32_32x32x16_bf16 v[32:47], v[88:91], v[148:151], v[32:47]
    ds_read_b64_tr_b16 v[252:253], v13 offset:35840
    ds_read_b64_tr_b16 v[254:255], v13 offset:36096
    buffer_load_dwordx4 v9, s[4:7], s66 offen offset:1024   lds
    s_waitcnt lgkmcnt(8)
    v_mfma_f32_32x32x16_bf16 v[48:63], v[148:151], v[92:95], v[48:63]
    buffer_load_dwordx4 v10, s[4:7], s66 offen offset:2048   lds
    s_waitcnt lgkmcnt(6)
    v_mfma_f32_32x32x16_bf16 v[32:47], v[240:243], v[152:155], v[32:47]
    buffer_load_dwordx4 v11, s[4:7], s66 offen offset:3072   lds
    s_add_u32 s59, s59, 1
    s_cmp_eq_u32 s59, 7
    s_cselect_b32 s59, 0, s59
    s_waitcnt lgkmcnt(4)
    v_mfma_f32_32x32x16_bf16 v[48:63], v[152:155], v[244:247], v[48:63]
    s_waitcnt vmcnt(5)
    s_barrier
    ds_read_b128 v[160:163], v16 offset:0
    ds_read_b64_tr_b16 v[80:81], v13 offset:8192
    ds_read_b64_tr_b16 v[82:83], v13 offset:8448
    ds_read_b64_tr_b16 v[84:85], v13 offset:36864
    ds_read_b64_tr_b16 v[86:87], v13 offset:37120
    ds_read_b64_tr_b16 v[88:89], v13 offset:9216
    ds_read_b64_tr_b16 v[90:91], v13 offset:9472
    ds_read_b128 v[164:167], v17 offset:0
    ds_read_b128 v[168:171], v18 offset:0
    ds_read_b128 v[172:175], v19 offset:0
    s_add_u32 m0, s63, 81920
    s_mul_i32 s65, s24, 172032
    s_add_u32 s65, s65, s61
    buffer_load_dwordx4 v12, s[8:11], s65 offen   lds
    s_add_u32 s24, s24, 1
    s_cmp_eq_u32 s24, 7
    s_cselect_b32 s24, 0, s24
    s_waitcnt lgkmcnt(12)
    v_mfma_f32_32x32x16_bf16 v[32:47], v[248:251], v[156:159], v[32:47]
    ds_read_b64_tr_b16 v[92:93], v13 offset:37888
    ds_read_b64_tr_b16 v[94:95], v13 offset:38144
    buffer_load_dwordx2 v[126:127], v6, s[32:35], 0 offen sc1
    s_waitcnt lgkmcnt(12)
    v_mfma_f32_32x32x16_bf16 v[48:63], v[156:159], v[252:255], v[48:63]
    ds_read_b64_tr_b16 v[240:241], v13 offset:10240
    ds_read_b64_tr_b16 v[242:243], v13 offset:10496
    s_waitcnt lgkmcnt(13)
    s_waitcnt lgkmcnt(11)
    v_mfma_f32_32x32x16_bf16 v[32:47], v[80:83], v[160:163], v[32:47]
    ds_read_b64_tr_b16 v[244:245], v13 offset:38912
    ds_read_b64_tr_b16 v[246:247], v13 offset:39168
    s_waitcnt lgkmcnt(11)
    v_mfma_f32_32x32x16_bf16 v[48:63], v[160:163], v[84:87], v[48:63]
    ds_read_b64_tr_b16 v[248:249], v13 offset:11264
    ds_read_b64_tr_b16 v[250:251], v13 offset:11520
    s_waitcnt lgkmcnt(8)
    s_lshl_b32 s66, s59, 7
    s_add_u32 m0, s62, 0
    s_add_u32 s66, s66, s60
    buffer_load_dwordx4 v8, s[4:7], s66 offen offset:0   lds
    v_mfma_f32_32x32x16_bf16 v[32:47], v[88:91], v[164:167], v[32:47]
    ds_read_b64_tr_b16 v[252:253], v13 offset:39936
    ds_read_b64_tr_b16 v[254:255], v13 offset:40192
    buffer_load_dwordx4 v9, s[4:7], s66 offen offset:1024   lds
    s_waitcnt lgkmcnt(8)
    v_mfma_f32_32x32x16_bf16 v[48:63], v[164:167], v[92:95], v[48:63]
    buffer_load_dwordx4 v10, s[4:7], s66 offen offset:2048   lds
    s_waitcnt lgkmcnt(6)
    v_mfma_f32_32x32x16_bf16 v[32:47], v[240:243], v[168:171], v[32:47]
    buffer_load_dwordx4 v11, s[4:7], s66 offen offset:3072   lds
    s_add_u32 s59, s59, 1
    s_cmp_eq_u32 s59, 7
    s_cselect_b32 s59, 0, s59
    s_waitcnt lgkmcnt(4)
    v_mfma_f32_32x32x16_bf16 v[48:63], v[168:171], v[244:247], v[48:63]
    s_waitcnt vmcnt(6)
    s_barrier
    ds_read_b128 v[176:179], v16 offset:32768
    ds_read_b64_tr_b16 v[80:81], v13 offset:12288
    ds_read_b64_tr_b16 v[82:83], v13 offset:12544
    ds_read_b64_tr_b16 v[84:85], v13 offset:40960
    ds_read_b64_tr_b16 v[86:87], v13 offset:41216
    ds_read_b64_tr_b16 v[88:89], v13 offset:13312
    ds_read_b64_tr_b16 v[90:91], v13 offset:13568
    ds_read_b128 v[180:183], v17 offset:32768
    ds_read_b128 v[184:187], v18 offset:32768
    ds_read_b128 v[188:191], v19 offset:32768
    s_add_u32 m0, s63, 86016
    s_mul_i32 s65, s24, 172032
    s_add_u32 s65, s65, s61
    buffer_load_dwordx4 v12, s[8:11], s65 offen   lds
    s_add_u32 s24, s24, 1
    s_cmp_eq_u32 s24, 7
    s_cselect_b32 s24, 0, s24
    s_waitcnt lgkmcnt(12)
    v_mfma_f32_32x32x16_bf16 v[32:47], v[248:251], v[172:175], v[32:47]
    ds_read_b64_tr_b16 v[92:93], v13 offset:41984
    ds_read_b64_tr_b16 v[94:95], v13 offset:42240
    s_waitcnt lgkmcnt(12)
    v_mfma_f32_32x32x16_bf16 v[48:63], v[172:175], v[252:255], v[48:63]
    ds_read_b64_tr_b16 v[240:241], v13 offset:14336
    ds_read_b64_tr_b16 v[242:243], v13 offset:14592
    s_waitcnt lgkmcnt(13)
    s_waitcnt lgkmcnt(11)
    v_mfma_f32_32x32x16_bf16 v[32:47], v[80:83], v[176:179], v[32:47]
    ds_read_b64_tr_b16 v[244:245], v13 offset:43008
    ds_read_b64_tr_b16 v[246:247], v13 offset:43264
    s_waitcnt lgkmcnt(11)
    v_mfma_f32_32x32x16_bf16 v[48:63], v[176:179], v[84:87], v[48:63]
    ds_read_b64_tr_b16 v[248:249], v13 offset:15360
    ds_read_b64_tr_b16 v[250:251], v13 offset:15616
    s_waitcnt lgkmcnt(8)
    s_lshl_b32 s66, s59, 7
    s_add_u32 m0, s62, 32768
    s_add_u32 s66, s66, s60
    buffer_load_dwordx4 v8, s[4:7], s66 offen offset:0   lds
    v_mfma_f32_32x32x16_bf16 v[32:47], v[88:91], v[180:183], v[32:47]
    ds_read_b64_tr_b16 v[252:253], v13 offset:44032
    ds_read_b64_tr_b16 v[254:255], v13 offset:44288
    buffer_load_dwordx4 v9, s[4:7], s66 offen offset:1024   lds
    s_waitcnt lgkmcnt(8)
    v_mfma_f32_32x32x16_bf16 v[48:63], v[180:183], v[92:95], v[48:63]
    buffer_load_dwordx4 v10, s[4:7], s66 offen offset:2048   lds
    s_waitcnt lgkmcnt(6)
    v_mfma_f32_32x32x16_bf16 v[32:47], v[240:243], v[184:187], v[32:47]
    buffer_load_dwordx4 v11, s[4:7], s66 offen offset:3072   lds
    s_add_u32 s59, s59, 1
    s_cmp_eq_u32 s59, 7
    s_cselect_b32 s59, 0, s59
    s_waitcnt lgkmcnt(4)
    v_mfma_f32_32x32x16_bf16 v[48:63], v[184:187], v[244:247], v[48:63]
    s_waitcnt vmcnt(5)
    s_barrier
    ds_read_b128 v[192:195], v16 offset:0
    ds_read_b64_tr_b16 v[80:81], v13 offset:16384
    ds_read_b64_tr_b16 v[82:83], v13 offset:16640
    ds_read_b64_tr_b16 v[84:85], v13 offset:45056
    ds_read_b64_tr_b16 v[86:87], v13 offset:45312
    ds_read_b64_tr_b16 v[88:89], v13 offset:17408
    ds_read_b64_tr_b16 v[90:91], v13 offset:17664
    ds_read_b128 v[196:199], v17 offset:0
    ds_read_b128 v[200:203], v18 offset:0
    ds_read_b128 v[204:207], v19 offset:0
    v_cmp_eq_u64 vcc, 0, v[126:127]
    s_cbranch_vccnz Lnonce_wait
Lnonce_ok:
    s_add_u32 m0, s63, 90112
    s_mul_i32 s65, s24, 172032
    s_add_u32 s65, s65, s61
    buffer_load_dwordx4 v12, s[8:11], s65 offen   lds
    s_waitcnt lgkmcnt(12)
    v_mfma_f32_32x32x16_bf16 v[32:47], v[248:251], v[188:191], v[32:47]
    ds_read_b64_tr_b16 v[92:93], v13 offset:46080
    ds_read_b64_tr_b16 v[94:95], v13 offset:46336
    s_waitcnt lgkmcnt(12)
    v_mfma_f32_32x32x16_bf16 v[48:63], v[188:191], v[252:255], v[48:63]
    ds_read_b64_tr_b16 v[240:241], v13 offset:18432
    ds_read_b64_tr_b16 v[242:243], v13 offset:18688
    s_waitcnt lgkmcnt(13)
    s_waitcnt lgkmcnt(11)
    v_mfma_f32_32x32x16_bf16 v[32:47], v[80:83], v[192:195], v[32:47]
    ds_read_b64_tr_b16 v[244:245], v13 offset:47104
    ds_read_b64_tr_b16 v[246:247], v13 offset:47360
    s_waitcnt lgkmcnt(11)
    v_mfma_f32_32x32x16_bf16 v[48:63], v[192:195], v[84:87], v[48:63]
    ds_read_b64_tr_b16 v[248:249], v13 offset:19456
    ds_read_b64_tr_b16 v[250:251], v13 offset:19712
    s_waitcnt lgkmcnt(8)
    s_lshl_b32 s66, s59, 7
    s_add_u32 m0, s62, 0
    s_add_u32 s66, s66, s60
    buffer_load_dwordx4 v8, s[4:7], s66 offen offset:0   lds
    v_mfma_f32_32x32x16_bf16 v[32:47], v[88:91], v[196:199], v[32:47]
    ds_read_b64_tr_b16 v[252:253], v13 offset:48128
    ds_read_b64_tr_b16 v[254:255], v13 offset:48384
    buffer_load_dwordx4 v9, s[4:7], s66 offen offset:1024   lds
    s_waitcnt lgkmcnt(8)
    v_mfma_f32_32x32x16_bf16 v[48:63], v[196:199], v[92:95], v[48:63]
    buffer_load_dwordx4 v10, s[4:7], s66 offen offset:2048   lds
    s_waitcnt lgkmcnt(6)
    v_mfma_f32_32x32x16_bf16 v[32:47], v[240:243], v[200:203], v[32:47]
    buffer_load_dwordx4 v11, s[4:7], s66 offen offset:3072   lds
    s_waitcnt lgkmcnt(4)
    v_mfma_f32_32x32x16_bf16 v[48:63], v[200:203], v[244:247], v[48:63]
    s_waitcnt vmcnt(5)
    s_barrier
    ds_read_b128 v[208:211], v16 offset:32768
    ds_read_b64_tr_b16 v[80:81], v13 offset:20480
    ds_read_b64_tr_b16 v[82:83], v13 offset:20736
    ds_read_b64_tr_b16 v[84:85], v13 offset:49152
    ds_read_b64_tr_b16 v[86:87], v13 offset:49408
    ds_read_b64_tr_b16 v[88:89], v13 offset:21504
    ds_read_b64_tr_b16 v[90:91], v13 offset:21760
    ds_read_b128 v[212:215], v17 offset:32768
    ds_read_b128 v[216:219], v18 offset:32768
    ds_read_b128 v[220:223], v19 offset:32768
    s_and_b32 s65, s53, 0x7fff
    s_add_u32 m0, s65, 131072
    s_mul_i32 s65, s39, 172032
    s_add_u32 s65, s65, s69
    buffer_load_dwordx4 v20, s[8:11], s65 offen   lds
    s_add_u32 s39, s39, 2
    s_cmp_ge_u32 s39, 7
    s_cselect_b32 s65, 7, 0
    s_sub_u32 s39, s39, s65
    s_waitcnt lgkmcnt(12)
    v_mfma_f32_32x32x16_bf16 v[32:47], v[248:251], v[204:207], v[32:47]
    ds_read_b64_tr_b16 v[92:93], v13 offset:50176
    ds_read_b64_tr_b16 v[94:95], v13 offset:50432
    s_add_u32 m0, s53, 139264
    s_mul_i32 s65, s39, 172032
    s_add_u32 s65, s65, s69
    buffer_load_dwordx4 v12, s[8:11], s65 offen   lds
    s_add_u32 s39, s39, 2
    s_cmp_ge_u32 s39, 7
    s_cselect_b32 s65, 7, 0
    s_sub_u32 s39, s39, s65
    s_waitcnt lgkmcnt(12)
    v_mfma_f32_32x32x16_bf16 v[48:63], v[204:207], v[252:255], v[48:63]
    ds_read_b64_tr_b16 v[240:241], v13 offset:22528
    ds_read_b64_tr_b16 v[242:243], v13 offset:22784
    s_waitcnt lgkmcnt(13)
    s_waitcnt lgkmcnt(11)
    v_mfma_f32_32x32x16_bf16 v[32:47], v[80:83], v[208:211], v[32:47]
    ds_read_b64_tr_b16 v[244:245], v13 offset:51200
    ds_read_b64_tr_b16 v[246:247], v13 offset:51456
    s_waitcnt lgkmcnt(11)
    v_mfma_f32_32x32x16_bf16 v[48:63], v[208:211], v[84:87], v[48:63]
    ds_read_b64_tr_b16 v[248:249], v13 offset:23552
    ds_read_b64_tr_b16 v[250:251], v13 offset:23808
    s_waitcnt lgkmcnt(10)
    v_mfma_f32_32x32x16_bf16 v[32:47], v[88:91], v[212:215], v[32:47]
    ds_read_b64_tr_b16 v[252:253], v13 offset:52224
    ds_read_b64_tr_b16 v[254:255], v13 offset:52480
    s_waitcnt lgkmcnt(8)
    v_mfma_f32_32x32x16_bf16 v[48:63], v[212:215], v[92:95], v[48:63]
    s_waitcnt lgkmcnt(6)
    v_mfma_f32_32x32x16_bf16 v[32:47], v[240:243], v[216:219], v[32:47]
    s_waitcnt lgkmcnt(4)
    v_mfma_f32_32x32x16_bf16 v[48:63], v[216:219], v[244:247], v[48:63]
    s_waitcnt vmcnt(2)
    s_barrier
    ds_read_b128 v[224:227], v16 offset:0
    ds_read_b64_tr_b16 v[80:81], v13 offset:24576
    ds_read_b64_tr_b16 v[82:83], v13 offset:24832
    ds_read_b64_tr_b16 v[84:85], v13 offset:53248
    ds_read_b64_tr_b16 v[86:87], v13 offset:53504
    ds_read_b64_tr_b16 v[88:89], v13 offset:25600
    ds_read_b64_tr_b16 v[90:91], v13 offset:25856
    ds_read_b128 v[228:231], v17 offset:0
    ds_read_b128 v[232:235], v18 offset:0
    ds_read_b128 v[236:239], v19 offset:0
    s_waitcnt lgkmcnt(12)
    v_mfma_f32_32x32x16_bf16 v[32:47], v[248:251], v[220:223], v[32:47]
    ds_read_b64_tr_b16 v[92:93], v13 offset:54272
    ds_read_b64_tr_b16 v[94:95], v13 offset:54528
    s_waitcnt lgkmcnt(12)
    v_mfma_f32_32x32x16_bf16 v[48:63], v[220:223], v[252:255], v[48:63]
    ds_read_b64_tr_b16 v[240:241], v13 offset:26624
    ds_read_b64_tr_b16 v[242:243], v13 offset:26880
    s_waitcnt lgkmcnt(13)
    s_waitcnt lgkmcnt(11)
    v_mfma_f32_32x32x16_bf16 v[32:47], v[80:83], v[224:227], v[32:47]
    ds_read_b64_tr_b16 v[244:245], v13 offset:55296
    ds_read_b64_tr_b16 v[246:247], v13 offset:55552
    s_waitcnt lgkmcnt(11)
    v_mfma_f32_32x32x16_bf16 v[48:63], v[224:227], v[84:87], v[48:63]
    ds_read_b64_tr_b16 v[248:249], v13 offset:27648
    ds_read_b64_tr_b16 v[250:251], v13 offset:27904
    s_waitcnt lgkmcnt(10)
    v_mfma_f32_32x32x16_bf16 v[32:47], v[88:91], v[228:231], v[32:47]
    ds_read_b64_tr_b16 v[252:253], v13 offset:56320
    ds_read_b64_tr_b16 v[254:255], v13 offset:56576
    s_waitcnt lgkmcnt(8)
    v_mfma_f32_32x32x16_bf16 v[48:63], v[228:231], v[92:95], v[48:63]
    s_waitcnt lgkmcnt(6)
    v_mfma_f32_32x32x16_bf16 v[32:47], v[240:243], v[232:235], v[32:47]
    s_waitcnt lgkmcnt(4)
    v_mfma_f32_32x32x16_bf16 v[48:63], v[232:235], v[244:247], v[48:63]
    s_waitcnt lgkmcnt(2)
    v_mfma_f32_32x32x16_bf16 v[32:47], v[248:251], v[236:239], v[32:47]
    s_waitcnt lgkmcnt(0)
    v_mfma_f32_32x32x16_bf16 v[48:63], v[236:239], v[252:255], v[48:63]
    s_lshl_b32 s61, s58, 7
    s_add_u32 s61, s61, s38
    s_nop 9
    v_cvt_pk_bf16_f32 v96, v32, v33
    v_cvt_pk_bf16_f32 v97, v34, v35
    v_cvt_pk_bf16_f32 v98, v36, v37
    v_cvt_pk_bf16_f32 v99, v38, v39
    v_cvt_pk_bf16_f32 v100, v40, v41
    v_cvt_pk_bf16_f32 v101, v42, v43
    v_cvt_pk_bf16_f32 v102, v44, v45
    v_cvt_pk_bf16_f32 v103, v46, v47
    v_cndmask_b32 v102, v102, v24, s[70:71]
    v_cndmask_b32 v103, v103, 0, s[70:71]
    buffer_store_dwordx4 v[96:99], v22, s[12:15], s68 offen offset:0 sc1
    buffer_store_dwordx4 v[100:103], v22, s[12:15], s68 offen offset:1024 sc1
    v_cvt_pk_bf16_f32 v104, v48, v49
    v_cvt_pk_bf16_f32 v105, v50, v51
    v_cvt_pk_bf16_f32 v106, v52, v53
    v_cvt_pk_bf16_f32 v107, v54, v55
    v_cvt_pk_bf16_f32 v108, v56, v57
    v_cvt_pk_bf16_f32 v109, v58, v59
    v_cvt_pk_bf16_f32 v110, v60, v61
    v_cvt_pk_bf16_f32 v111, v62, v63
    v_cndmask_b32 v104, v104, v25, s[72:73]
    v_cndmask_b32 v105, v105, v25, s[72:73]
    v_cndmask_b32 v106, v106, v25, s[72:73]
    v_cndmask_b32 v107, v107, v25, s[72:73]
    v_cndmask_b32 v108, v108, v25, s[72:73]
    v_cndmask_b32 v109, v109, v25, s[72:73]
    v_cndmask_b32 v110, v110, v25, s[72:73]
    v_cndmask_b32 v111, v111, v25, s[72:73]
    buffer_store_dwordx4 v[104:107], v1, s[12:15], s68 offen offset:2048 sc1
    buffer_store_dwordx4 v[108:111], v1, s[12:15], s68 offen offset:3072 sc1
    s_waitcnt vmcnt(4)
    s_mov_b64 exec, 0xffff
    ds_write_b16 v21, v122
    s_mov_b64 exec, -1
    s_mov_b64 exec, 0xffff0000
    ds_write_b16 v21, v122
    s_mov_b64 exec, -1
    ds_write_b128 v23, v[96:99] offset:0
    ds_write_b128 v23, v[100:103] offset:1024
    ds_write_b128 v26, v[104:107] offset:2048
    ds_write_b128 v26, v[108:111] offset:3072
    s_waitcnt lgkmcnt(4)
    s_barrier
    ds_read_b64_tr_b16 v[80:81], v14 offset:0
    ds_read_b64_tr_b16 v[82:83], v14 offset:256
    ds_read_b64_tr_b16 v[84:85], v14 offset:1024
    ds_read_b64_tr_b16 v[86:87], v14 offset:1280
    ds_read_b64_tr_b16 v[88:89], v14 offset:2048
    ds_read_b64_tr_b16 v[90:91], v14 offset:2304
    ds_read_b64_tr_b16 v[92:93], v14 offset:3072
    ds_read_b64_tr_b16 v[94:95], v14 offset:3328
    ds_read_b64_tr_b16 v[240:241], v14 offset:4096
    ds_read_b64_tr_b16 v[242:243], v14 offset:4352
    s_waitcnt lgkmcnt(8)
    v_mfma_f32_32x32x16_bf16 v[64:79], v[80:83], v[128:131], 0
    ds_read_b64_tr_b16 v[244:245], v14 offset:5120
    ds_read_b64_tr_b16 v[246:247], v14 offset:5376
    s_add_u32 m0, s53, 147456
    s_mul_i32 s65, s39, 172032
    s_add_u32 s65, s65, s69
    buffer_load_dwordx4 v12, s[8:11], s65 offen   lds
    s_add_u32 s39, s39, 2
    s_cmp_ge_u32 s39, 7
    s_cselect_b32 s65, 7, 0
    s_sub_u32 s39, s39, s65
    s_waitcnt lgkmcnt(8)
    v_mfma_f32_32x32x16_bf16 v[64:79], v[84:87], v[132:135], v[64:79]
    ds_read_b64_tr_b16 v[248:249], v14 offset:6144
    ds_read_b64_tr_b16 v[250:251], v14 offset:6400
    s_waitcnt lgkmcnt(8)
    v_mfma_f32_32x32x16_bf16 v[64:79], v[88:91], v[136:139], v[64:79]
    ds_read_b64_tr_b16 v[252:253], v14 offset:7168
    ds_read_b64_tr_b16 v[254:255], v14 offset:7424
    s_add_u32 m0, s53, 155648
    s_mul_i32 s65, s39, 172032
    s_add_u32 s65, s65, s69
    buffer_load_dwordx4 v12, s[8:11], s65 offen   lds
    s_waitcnt lgkmcnt(8)
    v_mfma_f32_32x32x16_bf16 v[64:79], v[92:95], v[140:143], v[64:79]
    ds_read_b64_tr_b16 v[80:81], v14 offset:8192
    ds_read_b64_tr_b16 v[82:83], v14 offset:8448
    s_waitcnt lgkmcnt(8)
    v_mfma_f32_32x32x16_bf16 v[64:79], v[240:243], v[144:147], v[64:79]
    ds_read_b64_tr_b16 v[84:85], v14 offset:9216
    ds_read_b64_tr_b16 v[86:87], v14 offset:9472
    s_waitcnt lgkmcnt(8)
    v_mfma_f32_32x32x16_bf16 v[64:79], v[244:247], v[148:151], v[64:79]
    ds_read_b64_tr_b16 v[88:89], v14 offset:10240
    ds_read_b64_tr_b16 v[90:91], v14 offset:10496
    s_waitcnt lgkmcnt(8)
    v_mfma_f32_32x32x16_bf16 v[64:79], v[248:251], v[152:155], v[64:79]
    ds_read_b64_tr_b16 v[92:93], v14 offset:11264
    ds_read_b64_tr_b16 v[94:95], v14 offset:11520
    s_waitcnt vmcnt(2)
    s_mov_b64 exec, 1
    buffer_store_dwordx2 v[126:127], v6, s[12:15], s61 offen sc1
    s_mov_b64 exec, -1
    s_waitcnt lgkmcnt(8)
    v_mfma_f32_32x32x16_bf16 v[64:79], v[252:255], v[156:159], v[64:79]
    s_waitcnt lgkmcnt(6)
    v_mfma_f32_32x32x16_bf16 v[64:79], v[80:83], v[160:163], v[64:79]
    ds_read_b128 v[112:115], v117 offset:16384
    s_waitcnt lgkmcnt(0)
    v_max3_u32 v112, v112, v113, v114
    v_max_u32 v112, v112, v115
    v_cmp_eq_u32 vcc, -1, v112
    s_cbranch_vccnz Llp_2
Llp_2_ret:
    s_mov_b32 exec_lo, 0
    s_mov_b32 exec_hi, 0xffff
    ds_write_b16 v21, v122
    s_mov_b64 exec, -1
    v_mfma_f32_32x32x16_bf16 v[64:79], v[84:87], v[164:167], v[64:79]
    s_waitcnt lgkmcnt(0)
    s_barrier
    ds_read_b64_tr_b16 v[240:241], v14 offset:12288
    ds_read_b64_tr_b16 v[242:243], v14 offset:12544
    ds_read_b64_tr_b16 v[244:245], v14 offset:13312
    ds_read_b64_tr_b16 v[246:247], v14 offset:13568
    ds_read_b64_tr_b16 v[248:249], v14 offset:14336
    ds_read_b64_tr_b16 v[250:251], v14 offset:14592
    v_mfma_f32_32x32x16_bf16 v[64:79], v[88:91], v[168:171], v[64:79]
    ds_read_b64_tr_b16 v[252:253], v14 offset:15360
    ds_read_b64_tr_b16 v[254:255], v14 offset:15616
    v_mfma_f32_32x32x16_bf16 v[64:79], v[92:95], v[172:175], v[64:79]
    ds_read_b64_tr_b16 v[80:81], v14 offset:16384
    ds_read_b64_tr_b16 v[82:83], v14 offset:16640
    s_waitcnt lgkmcnt(8)
    v_mfma_f32_32x32x16_bf16 v[64:79], v[240:243], v[176:179], v[64:79]
    ds_read_b64_tr_b16 v[84:85], v14 offset:17408
    ds_read_b64_tr_b16 v[86:87], v14 offset:17664
    s_waitcnt lgkmcnt(8)
    v_mfma_f32_32x32x16_bf16 v[64:79], v[244:247], v[180:183], v[64:79]
    ds_read_b64_tr_b16 v[88:89], v14 offset:18432
    ds_read_b64_tr_b16 v[90:91], v14 offset:18688
    s_waitcnt lgkmcnt(8)
    v_mfma_f32_32x32x16_bf16 v[64:79], v[248:251], v[184:187], v[64:79]
    ds_read_b64_tr_b16 v[92:93], v14 offset:19456
    ds_read_b64_tr_b16 v[94:95], v14 offset:19712
    s_waitcnt lgkmcnt(8)
    v_mfma_f32_32x32x16_bf16 v[64:79], v[252:255], v[188:191], v[64:79]
    s_waitcnt lgkmcnt(6)
    v_mfma_f32_32x32x16_bf16 v[64:79], v[80:83], v[192:195], v[64:79]
    ds_read_b128 v[112:115], v117 offset:24576
    s_waitcnt lgkmcnt(0)
    v_max3_u32 v112, v112, v113, v114
    v_max_u32 v112, v112, v115
    v_cmp_eq_u32 vcc, -1, v112
    s_cbranch_vccnz Llp_3
Llp_3_ret:
    s_mov_b32 exec_lo, 0
    s_mov_b32 exec_hi, 0xffff0000
    ds_write_b16 v21, v122
    s_mov_b64 exec, -1
    v_mfma_f32_32x32x16_bf16 v[64:79], v[84:87], v[196:199], v[64:79]
    s_waitcnt lgkmcnt(0)
    s_barrier
    ds_read_b64_tr_b16 v[240:241], v14 offset:20480
    ds_read_b64_tr_b16 v[242:243], v14 offset:20736
    ds_read_b64_tr_b16 v[244:245], v14 offset:21504
    ds_read_b64_tr_b16 v[246:247], v14 offset:21760
    ds_read_b64_tr_b16 v[248:249], v14 offset:22528
    ds_read_b64_tr_b16 v[250:251], v14 offset:22784
    v_mfma_f32_32x32x16_bf16 v[64:79], v[88:91], v[200:203], v[64:79]
    ds_read_b64_tr_b16 v[252:253], v14 offset:23552
    ds_read_b64_tr_b16 v[254:255], v14 offset:23808
    v_mfma_f32_32x32x16_bf16 v[64:79], v[92:95], v[204:207], v[64:79]
    ds_read_b64_tr_b16 v[80:81], v14 offset:24576
    ds_read_b64_tr_b16 v[82:83], v14 offset:24832
    s_waitcnt lgkmcnt(8)
    v_mfma_f32_32x32x16_bf16 v[64:79], v[240:243], v[208:211], v[64:79]
    ds_read_b64_tr_b16 v[84:85], v14 offset:25600
    ds_read_b64_tr_b16 v[86:87], v14 offset:25856
    s_waitcnt lgkmcnt(8)
    v_mfma_f32_32x32x16_bf16 v[64:79], v[244:247], v[212:215], v[64:79]
    ds_read_b64_tr_b16 v[88:89], v14 offset:26624
    ds_read_b64_tr_b16 v[90:91], v14 offset:26880
    s_waitcnt lgkmcnt(8)
    v_mfma_f32_32x32x16_bf16 v[64:79], v[248:251], v[216:219], v[64:79]
    ds_read_b64_tr_b16 v[92:93], v14 offset:27648
    ds_read_b64_tr_b16 v[94:95], v14 offset:27904
    s_waitcnt lgkmcnt(8)
    v_mfma_f32_32x32x16_bf16 v[64:79], v[252:255], v[220:223], v[64:79]
    s_waitcnt lgkmcnt(6)
    v_mfma_f32_32x32x16_bf16 v[64:79], v[80:83], v[224:227], v[64:79]
    s_waitcnt lgkmcnt(4)
    v_mfma_f32_32x32x16_bf16 v[64:79], v[84:87], v[228:231], v[64:79]
    s_waitcnt lgkmcnt(2)
    v_mfma_f32_32x32x16_bf16 v[64:79], v[88:91], v[232:235], v[64:79]
    s_waitcnt lgkmcnt(0)
    v_mfma_f32_32x32x16_bf16 v[64:79], v[92:95], v[236:239], v[64:79]
    s_nop 11
    v_mul_f32 v7, 0xbfb8aa3b, v76
    v_pk_mul_f32 v[64:65], v[64:65], s[76:77]
    v_pk_mul_f32 v[66:67], v[66:67], s[76:77]
    v_pk_mul_f32 v[68:69], v[68:69], s[76:77]
    v_pk_mul_f32 v[70:71], v[70:71], s[76:77]
    v_pk_mul_f32 v[72:73], v[72:73], s[76:77]
    v_pk_mul_f32 v[74:75], v[74:75], s[76:77]
    v_pk_mul_f32 v[76:77], v[76:77], s[76:77]
    v_pk_mul_f32 v[78:79], v[78:79], s[76:77]
    v_exp_f32 v7, v7
    v_cvt_pk_bf16_f32 v8, v64, v65
    v_cvt_pk_bf16_f32 v9, v66, v67
    v_cvt_pk_bf16_f32 v10, v68, v69
    v_cvt_pk_bf16_f32 v11, v70, v71
    v_cvt_pk_bf16_f32 v12, v72, v73
    v_cvt_pk_bf16_f32 v13, v74, v75
    v_cvt_pk_bf16_f32 v14, v76, v77
    v_cvt_pk_bf16_f32 v15, v78, v79
    v_cndmask_b32 v14, v14, 0, s[70:71]
    v_cndmask_b32 v15, v15, 0, s[70:71]
    v_add_f32 v7, 1.0, v7
    v_mfma_f32_32x32x16_bf16 v[48:63], v[96:99], v[8:11], 0
    v_mfma_f32_32x32x16_bf16 v[48:63], v[100:103], v[12:15], v[48:63]
    ds_write_b128 v28, v[8:11]
    v_rcp_f32 v7, v7
    v_mov_b32 v24, s41
    v_and_b32 v122, 31, v2
    v_fma_f32 v7, s40, v7, v24
    v_lshlrev_b32 v122, 3, v122
    buffer_load_dwordx2 v[4:5], v123, s[12:15], s38 offen sc1
    s_nop 6
    v_max3_f32 v112, v48, v49, v50
    v_max3_f32 v113, v51, v52, v53
    v_max3_f32 v114, v54, v55, v56
    v_max3_f32 v115, v57, v58, v59
    v_max3_f32 v112, v112, v60, v61
    v_max3_f32 v113, v113, v62, v63
    v_max3_f32 v112, v112, v114, v115
    v_max_f32 v112, v112, v113
    v_mov_b32 v113, v112
    s_nop 1
    v_permlane32_swap_b32 v112, v113
    s_nop 1
    v_max_f32 v112, v112, v113
    v_cvt_pk_bf16_f32 v112, -v112, 0
    v_cndmask_b32 v14, v14, v112, s[70:71]
    ds_write_b128 v28, v[12:15] offset:1024
    s_waitcnt lgkmcnt(0)
    s_barrier
    s_setprio 2
    ds_read_b128 v[96:99], v120 offset:0
    ds_read_b128 v[100:103], v120 offset:1024
    ds_read_b128 v[16:19], v27
    ds_read_b128 v[20:23], v27 offset:1024
    s_cmp_ge_u32 s52, 98304
    s_cbranch_scc1 Lchk_1
    v_cmp_eq_u64 s[74:75], v[4:5], v[126:127]
    s_and_b32 s64, s74, s42
    s_cbranch_scc1 Lgo_1
Lgo_1_ret:
    buffer_load_dwordx2 v[4:5], v123, s[12:15], s38 offen sc1
Lchk_1:
    v_mov_b32 v252, -1
    v_mov_b32 v253, -1
    v_mov_b32 v254, -1
    v_mov_b32 v255, -1
    v_add_u32 v116, s62, v1
    v_xor_b32 v117, 0x4000, v116
    s_waitcnt lgkmcnt(3)
    v_mfma_f32_32x32x16_bf16 v[32:47], v[96:99], v[8:11], 0
    s_waitcnt lgkmcnt(2)
    v_mfma_f32_32x32x16_bf16 v[32:47], v[100:103], v[12:15], v[32:47]
    v_mov_b64 v[64:65], 0
    v_mov_b64 v[66:67], 0
    v_mov_b64 v[68:69], 0
    v_mov_b64 v[70:71], 0
    v_mov_b64 v[72:73], 0
    v_mov_b64 v[74:75], 0
    v_mov_b64 v[76:77], 0
    v_mov_b64 v[78:79], 0
    ds_read_b128 v[24:27], v120 offset:2048
    v_mov_b64 v[80:81], 0
    v_mov_b64 v[82:83], 0
    v_mov_b64 v[84:85], 0
    v_mov_b64 v[86:87], 0
    v_mov_b64 v[88:89], 0
    v_mov_b64 v[90:91], 0
    v_mov_b64 v[92:93], 0
    v_mov_b64 v[94:95], 0
    ds_read_b128 v[112:115], v120 offset:3072
    s_setprio 0
    v_exp_f32 v32, v32
    s_setprio 1
    v_exp_f32 v33, v33
    v_exp_f32 v34, v34
    v_exp_f32 v35, v35
    v_exp_f32 v36, v36
    v_exp_f32 v37, v37
    v_exp_f32 v38, v38
    v_exp_f32 v39, v39
    v_exp_f32 v40, v40
    v_exp_f32 v41, v41
    v_exp_f32 v42, v42
    v_exp_f32 v43, v43
    v_exp_f32 v44, v44
    v_exp_f32 v45, v45
    v_exp_f32 v46, v46
    v_exp_f32 v47, v47
    s_setprio 2
    s_waitcnt lgkmcnt(2)
    v_mfma_f32_32x32x16_bf16 v[48:63], v[96:99], v[16:19], 0
    ds_read_b128 v[96:99], v120 offset:4096
    v_mfma_f32_32x32x16_bf16 v[48:63], v[100:103], v[20:23], v[48:63]
    ds_read_b128 v[100:103], v120 offset:5120
    s_nop 4
    s_waitcnt lgkmcnt(3)
    v_smfmac_f32_32x32x32_bf16 v[64:79], v[24:27], v[32:39], v31
    s_nop 0
    s_waitcnt lgkmcnt(2)
    v_smfmac_f32_32x32x32_bf16 v[64:79], v[112:115], v[40:47], v31
    s_setprio 0
    v_exp_f32 v48, v48
    s_setprio 1
    v_exp_f32 v49, v49
    v_exp_f32 v50, v50
    v_exp_f32 v51, v51
    v_exp_f32 v52, v52
    v_exp_f32 v53, v53
    v_exp_f32 v54, v54
    v_exp_f32 v55, v55
    v_exp_f32 v56, v56
    v_exp_f32 v57, v57
    v_exp_f32 v58, v58
    v_exp_f32 v59, v59
    v_exp_f32 v60, v60
    v_exp_f32 v61, v61
    v_exp_f32 v62, v62
    v_exp_f32 v63, v63
    s_setprio 2
    s_waitcnt lgkmcnt(1)
    v_mfma_f32_32x32x16_bf16 v[32:47], v[96:99], v[8:11], 0
    s_cmp_ge_u32 s52, 98304
    s_cbranch_scc1 Lchk_2
    v_cmp_eq_u64 s[74:75], v[4:5], v[126:127]
    s_and_b32 s64, s74, s42
    s_cbranch_scc1 Lgo_2
Lgo_2_ret:
    buffer_load_dwordx2 v[4:5], v123, s[12:15], s38 offen sc1
Lchk_2:
    s_waitcnt lgkmcnt(0)
    v_mfma_f32_32x32x16_bf16 v[32:47], v[100:103], v[12:15], v[32:47]
    s_nop 5
    v_smfmac_f32_32x32x32_bf16 v[80:95], v[24:27], v[48:55], v31
    ds_read_b128 v[104:107], v120 offset:6144
    s_nop 0
    v_smfmac_f32_32x32x32_bf16 v[80:95], v[112:115], v[56:63], v31
    ds_read_b128 v[108:111], v120 offset:7168
    s_setprio 0
    v_exp_f32 v32, v32
    s_setprio 1
    v_exp_f32 v33, v33
    v_exp_f32 v34, v34
    v_exp_f32 v35, v35
    v_exp_f32 v36, v36
    v_exp_f32 v37, v37
    v_exp_f32 v38, v38
    v_exp_f32 v39, v39
    v_exp_f32 v40, v40
    v_exp_f32 v41, v41
    v_exp_f32 v42, v42
    v_exp_f32 v43, v43
    v_exp_f32 v44, v44
    v_exp_f32 v45, v45
    v_exp_f32 v46, v46
    v_exp_f32 v47, v47
    s_setprio 2
    v_mfma_f32_32x32x16_bf16 v[48:63], v[96:99], v[16:19], 0
    ds_read_b128 v[96:99], v120 offset:8192
    s_cmp_ge_u32 s52, 98304
    s_cbranch_scc1 Lchk_3
    v_cmp_eq_u64 s[74:75], v[4:5], v[126:127]
    s_and_b32 s64, s74, s42
    s_cbranch_scc1 Lgo_3
Lgo_3_ret:
    buffer_load_dwordx2 v[4:5], v123, s[12:15], s38 offen sc1
Lchk_3:
    v_mfma_f32_32x32x16_bf16 v[48:63], v[100:103], v[20:23], v[48:63]
    ds_read_b128 v[100:103], v120 offset:9216
    s_nop 4
    s_waitcnt lgkmcnt(3)
    v_smfmac_f32_32x32x32_bf16 v[64:79], v[104:107], v[32:39], v31
    s_nop 0
    s_waitcnt lgkmcnt(2)
    v_smfmac_f32_32x32x32_bf16 v[64:79], v[108:111], v[40:47], v31
    s_setprio 0
    v_exp_f32 v48, v48
    s_setprio 1
    v_exp_f32 v49, v49
    v_exp_f32 v50, v50
    v_exp_f32 v51, v51
    v_exp_f32 v52, v52
    v_exp_f32 v53, v53
    v_exp_f32 v54, v54
    v_exp_f32 v55, v55
    v_exp_f32 v56, v56
    v_exp_f32 v57, v57
    v_exp_f32 v58, v58
    v_exp_f32 v59, v59
    v_exp_f32 v60, v60
    v_exp_f32 v61, v61
    v_exp_f32 v62, v62
    v_exp_f32 v63, v63
    s_setprio 2
    s_waitcnt lgkmcnt(1)
    v_mfma_f32_32x32x16_bf16 v[32:47], v[96:99], v[8:11], 0
    s_cmp_ge_u32 s52, 98304
    s_cbranch_scc1 Lchk_4
    v_cmp_eq_u64 s[74:75], v[4:5], v[126:127]
    s_and_b32 s64, s74, s42
    s_cbranch_scc1 Lgo_4
Lgo_4_ret:
    buffer_load_dwordx2 v[4:5], v123, s[12:15], s38 offen sc1
Lchk_4:
    s_waitcnt lgkmcnt(0)
    v_mfma_f32_32x32x16_bf16 v[32:47], v[100:103], v[12:15], v[32:47]
    s_nop 5
    v_smfmac_f32_32x32x32_bf16 v[80:95], v[104:107], v[48:55], v31
    ds_read_b128 v[24:27], v120 offset:10240
    s_nop 0
    v_smfmac_f32_32x32x32_bf16 v[80:95], v[108:111], v[56:63], v31
    ds_read_b128 v[112:115], v120 offset:11264
    s_setprio 0
    v_exp_f32 v32, v32
    s_setprio 1
    v_exp_f32 v33, v33
    v_exp_f32 v34, v34
    v_exp_f32 v35, v35
    v_exp_f32 v36, v36
    v_exp_f32 v37, v37
    v_exp_f32 v38, v38
    v_exp_f32 v39, v39
    v_exp_f32 v40, v40
    v_exp_f32 v41, v41
    v_exp_f32 v42, v42
    v_exp_f32 v43, v43
    v_exp_f32 v44, v44
    v_exp_f32 v45, v45
    v_exp_f32 v46, v46
    v_exp_f32 v47, v47
    s_setprio 2
    v_mfma_f32_32x32x16_bf16 v[48:63], v[96:99], v[16:19], 0
    ds_read_b128 v[96:99], v120 offset:12288
    s_cmp_ge_u32 s52, 98304
    s_cbranch_scc1 Lchk_5
    v_cmp_eq_u64 s[74:75], v[4:5], v[126:127]
    s_and_b32 s64, s74, s42
    s_cbranch_scc1 Lgo_5
Lgo_5_ret:
Lchk_5:
    buffer_load_dwordx2 v[4:5], v123, s[12:15], s38 offen sc1
    v_mfma_f32_32x32x16_bf16 v[48:63], v[100:103], v[20:23], v[48:63]
    ds_read_b128 v[100:103], v120 offset:13312
    s_nop 3
    s_waitcnt lgkmcnt(3)
    v_smfmac_f32_32x32x32_bf16 v[64:79], v[24:27], v[32:39], v31
    ds_read_b128 v[104:107], v120 offset:14336
    s_waitcnt lgkmcnt(3)
    v_smfmac_f32_32x32x32_bf16 v[64:79], v[112:115], v[40:47], v31
    ds_read_b128 v[108:111], v120 offset:15360
    s_setprio 0
    v_exp_f32 v48, v48
    s_setprio 1
    v_exp_f32 v49, v49
    v_exp_f32 v50, v50
    v_exp_f32 v51, v51
    v_exp_f32 v52, v52
    v_exp_f32 v53, v53
    v_exp_f32 v54, v54
    v_exp_f32 v55, v55
    v_exp_f32 v56, v56
    v_exp_f32 v57, v57
    v_exp_f32 v58, v58
    v_exp_f32 v59, v59
    v_exp_f32 v60, v60
    v_exp_f32 v61, v61
    v_exp_f32 v62, v62
    v_exp_f32 v63, v63
    s_setprio 2
    s_waitcnt lgkmcnt(3)
    v_mfma_f32_32x32x16_bf16 v[32:47], v[96:99], v[8:11], 0
    s_cmp_ge_u32 s52, 98304
    s_cbranch_scc1 Lchk_6
    v_cmp_eq_u64 s[74:75], v[4:5], v[126:127]
    s_and_b32 s64, s74, s42
    s_cbranch_scc1 Lgo_6
Lgo_6_ret:
    buffer_load_dwordx2 v[4:5], v123, s[12:15], s38 offen sc1
Lchk_6:
    s_waitcnt lgkmcnt(2)
    v_mfma_f32_32x32x16_bf16 v[32:47], v[100:103], v[12:15], v[32:47]
    s_nop 4
    v_smfmac_f32_32x32x32_bf16 v[80:95], v[24:27], v[48:55], v31
    v_smfmac_f32_32x32x32_bf16 v[80:95], v[112:115], v[56:63], v31
    s_setprio 0
    s_cmp_ge_u32 s52, 98304
    s_cbranch_scc0 Lspin0
Lspin0_ret:
    s_cmp_lt_u32 s56, 4
    s_cbranch_scc1 Lbar_6
    s_waitcnt vmcnt(4) lgkmcnt(0)
    s_barrier
Lbar_6:
    v_exp_f32 v32, v32
    s_setprio 1
    v_exp_f32 v33, v33
    v_exp_f32 v34, v34
    v_exp_f32 v35, v35
    v_exp_f32 v36, v36
    v_exp_f32 v37, v37
    v_exp_f32 v38, v38
    v_exp_f32 v39, v39
    v_exp_f32 v40, v40
    v_exp_f32 v41, v41
    v_exp_f32 v42, v42
    v_exp_f32 v43, v43
    v_exp_f32 v44, v44
    v_exp_f32 v45, v45
    v_exp_f32 v46, v46
    v_exp_f32 v47, v47
    s_cbranch_scc0 Lbarl_7
    s_waitcnt vmcnt(4) lgkmcnt(0)
    s_barrier
Lbarl_7:
    s_setprio 2
    v_mfma_f32_32x32x16_bf16 v[48:63], v[96:99], v[16:19], 0
    ds_read_b128 v[96:99], v120 offset:32768
    v_cmp_eq_u64 s[74:75], v[4:5], v[126:127]
    s_and_b32 s64, s74, s42
    s_cbranch_scc0 Lslow_0
Lslow_0_ret:
    s_ff1_i32_b32 s64, s64
    s_add_u32 m0, s62, 0
    s_bitset0_b32 s42, s64
    s_lshl_b32 s64, s64, 15
    s_add_u32 s64, s64, s68
    s_and_b32 s64, s64, 0x3ffff
    s_or_b32 s48, s64, s47
    v_mfma_f32_32x32x16_bf16 v[48:63], v[100:103], v[20:23], v[48:63]
    ds_read_b128 v[100:103], v120 offset:33792
    buffer_load_dwordx4 v1, s[12:15], s48 offen offset:0 sc1 lds
    s_nop 3
    v_smfmac_f32_32x32x32_bf16 v[64:79], v[104:107], v[32:39], v31
    s_nop 1
    v_smfmac_f32_32x32x32_bf16 v[64:79], v[108:111], v[40:47], v31
    buffer_load_dwordx4 v1, s[12:15], s48 offen offset:1024 sc1 lds
    s_setprio 0
    v_exp_f32 v48, v48
    s_setprio 1
    v_exp_f32 v49, v49
    v_exp_f32 v50, v50
    v_exp_f32 v51, v51
    v_exp_f32 v52, v52
    v_exp_f32 v53, v53
    v_exp_f32 v54, v54
    v_exp_f32 v55, v55
    v_exp_f32 v56, v56
    v_exp_f32 v57, v57
    v_exp_f32 v58, v58
    v_exp_f32 v59, v59
    v_exp_f32 v60, v60
    v_exp_f32 v61, v61
    v_exp_f32 v62, v62
    v_exp_f32 v63, v63
    s_setprio 2
    s_waitcnt lgkmcnt(1)
    v_mfma_f32_32x32x16_bf16 v[32:47], v[96:99], v[8:11], 0
    s_waitcnt lgkmcnt(0)
    v_mfma_f32_32x32x16_bf16 v[32:47], v[100:103], v[12:15], v[32:47]
    buffer_load_dwordx4 v1, s[12:15], s48 offen offset:2048 sc1 lds
    s_nop 4
    v_smfmac_f32_32x32x32_bf16 v[80:95], v[104:107], v[48:55], v31
    ds_read_b128 v[24:27], v120 offset:34816
    v_smfmac_f32_32x32x32_bf16 v[80:95], v[108:111], v[56:63], v31
    ds_read_b128 v[112:115], v120 offset:35840
    buffer_load_dwordx4 v1, s[12:15], s48 offen offset:3072 sc1 lds
    s_setprio 0
    v_exp_f32 v32, v32
    s_setprio 1
    v_exp_f32 v33, v33
    v_exp_f32 v34, v34
    v_exp_f32 v35, v35
    v_exp_f32 v36, v36
    v_exp_f32 v37, v37
    v_exp_f32 v38, v38
    v_exp_f32 v39, v39
    v_exp_f32 v40, v40
    v_exp_f32 v41, v41
    v_exp_f32 v42, v42
    v_exp_f32 v43, v43
    v_exp_f32 v44, v44
    v_exp_f32 v45, v45
    v_exp_f32 v46, v46
    v_exp_f32 v47, v47
    s_setprio 2
    v_mfma_f32_32x32x16_bf16 v[48:63], v[96:99], v[16:19], 0
    ds_read_b128 v[96:99], v120 offset:36864
    v_mfma_f32_32x32x16_bf16 v[48:63], v[100:103], v[20:23], v[48:63]
    ds_read_b128 v[100:103], v120 offset:37888
    buffer_load_dwordx2 v[4:5], v123, s[12:15], s38 offen sc1
    s_nop 1
    s_waitcnt lgkmcnt(3)
    v_smfmac_f32_32x32x32_bf16 v[64:79], v[24:27], v[32:39], v31
    s_waitcnt lgkmcnt(2)
    v_smfmac_f32_32x32x32_bf16 v[64:79], v[112:115], v[40:47], v31
    s_add_u32 m0, s37, 0
    s_add_u32 s64, s79, 0
    buffer_load_dwordx4 v124, s[20:23], s64 offen offset:0 lds
    s_setprio 0
    v_exp_f32 v48, v48
    s_setprio 1
    v_exp_f32 v49, v49
    v_exp_f32 v50, v50
    v_exp_f32 v51, v51
    v_exp_f32 v52, v52
    v_exp_f32 v53, v53
    v_exp_f32 v54, v54
    v_exp_f32 v55, v55
    v_exp_f32 v56, v56
    v_exp_f32 v57, v57
    v_exp_f32 v58, v58
    v_exp_f32 v59, v59
    v_exp_f32 v60, v60
    v_exp_f32 v61, v61
    v_exp_f32 v62, v62
    v_exp_f32 v63, v63
    s_setprio 2
    s_waitcnt lgkmcnt(1)
    v_mfma_f32_32x32x16_bf16 v[32:47], v[96:99], v[8:11], 0
    s_waitcnt lgkmcnt(0)
    v_mfma_f32_32x32x16_bf16 v[32:47], v[100:103], v[12:15], v[32:47]
    s_add_u32 s64, s79, 6144
    buffer_load_dwordx4 v124, s[20:23], s64 offen offset:1024 lds
    s_nop 2
    v_smfmac_f32_32x32x32_bf16 v[80:95], v[24:27], v[48:55], v31
    ds_read_b128 v[104:107], v120 offset:38912
    v_smfmac_f32_32x32x32_bf16 v[80:95], v[112:115], v[56:63], v31
    ds_read_b128 v[108:111], v120 offset:39936
    s_add_u32 s64, s79, 12288
    buffer_load_dwordx4 v124, s[20:23], s64 offen offset:2048 lds
    s_setprio 0
    v_exp_f32 v32, v32
    s_setprio 1
    v_exp_f32 v33, v33
    v_exp_f32 v34, v34
    v_exp_f32 v35, v35
    v_exp_f32 v36, v36
    v_exp_f32 v37, v37
    v_exp_f32 v38, v38
    v_exp_f32 v39, v39
    v_exp_f32 v40, v40
    v_exp_f32 v41, v41
    v_exp_f32 v42, v42
    v_exp_f32 v43, v43
    v_exp_f32 v44, v44
    v_exp_f32 v45, v45
    v_exp_f32 v46, v46
    v_exp_f32 v47, v47
    s_setprio 2
    v_mfma_f32_32x32x16_bf16 v[48:63], v[96:99], v[16:19], 0
    ds_read_b128 v[96:99], v120 offset:40960
    v_mfma_f32_32x32x16_bf16 v[48:63], v[100:103], v[20:23], v[48:63]
    ds_read_b128 v[100:103], v120 offset:41984
    s_add_u32 s64, s79, 18432
    buffer_load_dwordx4 v124, s[20:23], s64 offen offset:3072 lds
    s_nop 0
    s_waitcnt lgkmcnt(3)
    v_smfmac_f32_32x32x32_bf16 v[64:79], v[104:107], v[32:39], v31
    s_waitcnt lgkmcnt(2)
    v_smfmac_f32_32x32x32_bf16 v[64:79], v[108:111], v[40:47], v31
    s_add_u32 m0, s37, 4096
    s_add_u32 s64, s79, 28672
    buffer_load_dwordx4 v124, s[20:23], s64 offen offset:0 lds
    s_setprio 0
    v_exp_f32 v48, v48
    s_setprio 1
    v_exp_f32 v49, v49
    v_exp_f32 v50, v50
    v_exp_f32 v51, v51
    v_exp_f32 v52, v52
    v_exp_f32 v53, v53
    v_exp_f32 v54, v54
    v_exp_f32 v55, v55
    v_exp_f32 v56, v56
    v_exp_f32 v57, v57
    v_exp_f32 v58, v58
    v_exp_f32 v59, v59
    v_exp_f32 v60, v60
    v_exp_f32 v61, v61
    v_exp_f32 v62, v62
    v_exp_f32 v63, v63
    s_setprio 2
    s_waitcnt lgkmcnt(1)
    v_mfma_f32_32x32x16_bf16 v[32:47], v[96:99], v[8:11], 0
    s_waitcnt lgkmcnt(0)
    v_mfma_f32_32x32x16_bf16 v[32:47], v[100:103], v[12:15], v[32:47]
    s_add_u32 s64, s79, 34816
    buffer_load_dwordx4 v124, s[20:23], s64 offen offset:1024 lds
    s_nop 2
    v_smfmac_f32_32x32x32_bf16 v[80:95], v[104:107], v[48:55], v31
    ds_read_b128 v[24:27], v120 offset:43008
    v_smfmac_f32_32x32x32_bf16 v[80:95], v[108:111], v[56:63], v31
    ds_read_b128 v[112:115], v120 offset:44032
    s_add_u32 s64, s79, 40960
    buffer_load_dwordx4 v124, s[20:23], s64 offen offset:2048 lds
    s_setprio 0
    v_exp_f32 v32, v32
    s_setprio 1
    v_exp_f32 v33, v33
    v_exp_f32 v34, v34
    v_exp_f32 v35, v35
    v_exp_f32 v36, v36
    v_exp_f32 v37, v37
    v_exp_f32 v38, v38
    v_exp_f32 v39, v39
    v_exp_f32 v40, v40
    v_exp_f32 v41, v41
    v_exp_f32 v42, v42
    v_exp_f32 v43, v43
    v_exp_f32 v44, v44
    v_exp_f32 v45, v45
    v_exp_f32 v46, v46
    v_exp_f32 v47, v47
    s_setprio 2
    v_mfma_f32_32x32x16_bf16 v[48:63], v[96:99], v[16:19], 0
    ds_read_b128 v[96:99], v120 offset:45056
    v_mfma_f32_32x32x16_bf16 v[48:63], v[100:103], v[20:23], v[48:63]
    ds_read_b128 v[100:103], v120 offset:46080
    s_nop 3
    s_waitcnt lgkmcnt(3)
    v_smfmac_f32_32x32x32_bf16 v[64:79], v[24:27], v[32:39], v31
    ds_read_b128 v[104:107], v120 offset:47104
    s_waitcnt lgkmcnt(3)
    v_smfmac_f32_32x32x32_bf16 v[64:79], v[112:115], v[40:47], v31
    ds_read_b128 v[108:111], v120 offset:48128
    s_setprio 0
    v_exp_f32 v48, v48
    s_setprio 1
    v_exp_f32 v49, v49
    v_exp_f32 v50, v50
    v_exp_f32 v51, v51
    v_exp_f32 v52, v52
    v_exp_f32 v53, v53
    v_exp_f32 v54, v54
    v_exp_f32 v55, v55
    v_exp_f32 v56, v56
    v_exp_f32 v57, v57
    v_exp_f32 v58, v58
    v_exp_f32 v59, v59
    v_exp_f32 v60, v60
    v_exp_f32 v61, v61
    v_exp_f32 v62, v62
    v_exp_f32 v63, v63
    s_setprio 2
    s_waitcnt lgkmcnt(3)
    v_mfma_f32_32x32x16_bf16 v[32:47], v[96:99], v[8:11], 0
    v_cmp_eq_u64 s[74:75], v[4:5], v[126:127]
    s_and_b32 s64, s74, s42
    s_cbranch_scc0 Lslow_1
Lslow_1_ret:
    s_ff1_i32_b32 s64, s64
    s_add_u32 m0, s62, 32768
    s_bitset0_b32 s42, s64
    s_lshl_b32 s64, s64, 15
    s_add_u32 s64, s64, s68
    s_and_b32 s64, s64, 0x3ffff
    s_or_b32 s48, s64, s47
    s_waitcnt lgkmcnt(2)
    v_mfma_f32_32x32x16_bf16 v[32:47], v[100:103], v[12:15], v[32:47]
    s_nop 5
    v_smfmac_f32_32x32x32_bf16 v[80:95], v[24:27], v[48:55], v31
    v_smfmac_f32_32x32x32_bf16 v[80:95], v[112:115], v[56:63], v31
    s_setprio 0
    s_cmp_lt_u32 s56, 4
    s_waitcnt vmcnt(12) lgkmcnt(0)
    s_cbranch_scc1 Lbar_14
    s_barrier
Lbar_14:
    v_exp_f32 v32, v32
    s_setprio 1
    v_exp_f32 v33, v33
    v_exp_f32 v34, v34
    v_exp_f32 v35, v35
    v_exp_f32 v36, v36
    v_exp_f32 v37, v37
    v_exp_f32 v38, v38
    v_exp_f32 v39, v39
    v_exp_f32 v40, v40
    v_exp_f32 v41, v41
    v_exp_f32 v42, v42
    v_exp_f32 v43, v43
    v_exp_f32 v44, v44
    v_exp_f32 v45, v45
    v_exp_f32 v46, v46
    v_exp_f32 v47, v47
    s_cbranch_scc0 Lbarl_15
    s_barrier
Lbarl_15:
    s_setprio 2
    v_mfma_f32_32x32x16_bf16 v[48:63], v[96:99], v[16:19], 0
    ds_read_b128 v[96:99], v121 offset:0
    v_mfma_f32_32x32x16_bf16 v[48:63], v[100:103], v[20:23], v[48:63]
    ds_read_b128 v[100:103], v121 offset:1024
    buffer_load_dwordx4 v1, s[12:15], s48 offen offset:0 sc1 lds
    s_nop 3
    v_smfmac_f32_32x32x32_bf16 v[64:79], v[104:107], v[32:39], v31
    s_nop 1
    v_smfmac_f32_32x32x32_bf16 v[64:79], v[108:111], v[40:47], v31
    buffer_load_dwordx4 v1, s[12:15], s48 offen offset:1024 sc1 lds
    s_setprio 0
    v_exp_f32 v48, v48
    s_setprio 1
    v_exp_f32 v49, v49
    v_exp_f32 v50, v50
    v_exp_f32 v51, v51
    v_exp_f32 v52, v52
    v_exp_f32 v53, v53
    v_exp_f32 v54, v54
    v_exp_f32 v55, v55
    v_exp_f32 v56, v56
    v_exp_f32 v57, v57
    v_exp_f32 v58, v58
    v_exp_f32 v59, v59
    v_exp_f32 v60, v60
    v_exp_f32 v61, v61
    v_exp_f32 v62, v62
    v_exp_f32 v63, v63
    s_setprio 2
    s_waitcnt lgkmcnt(1)
    v_mfma_f32_32x32x16_bf16 v[32:47], v[96:99], v[8:11], 0
    s_waitcnt lgkmcnt(0)
    v_mfma_f32_32x32x16_bf16 v[32:47], v[100:103], v[12:15], v[32:47]
    buffer_load_dwordx4 v1, s[12:15], s48 offen offset:2048 sc1 lds
    s_nop 4
    v_smfmac_f32_32x32x32_bf16 v[80:95], v[104:107], v[48:55], v31
    ds_read_b128 v[24:27], v121 offset:2048
    v_smfmac_f32_32x32x32_bf16 v[80:95], v[108:111], v[56:63], v31
    ds_read_b128 v[112:115], v121 offset:3072
    buffer_load_dwordx4 v1, s[12:15], s48 offen offset:3072 sc1 lds
    s_setprio 0
    v_exp_f32 v32, v32
    s_setprio 1
    v_exp_f32 v33, v33
    v_exp_f32 v34, v34
    v_exp_f32 v35, v35
    v_exp_f32 v36, v36
    v_exp_f32 v37, v37
    v_exp_f32 v38, v38
    v_exp_f32 v39, v39
    v_exp_f32 v40, v40
    v_exp_f32 v41, v41
    v_exp_f32 v42, v42
    v_exp_f32 v43, v43
    v_exp_f32 v44, v44
    v_exp_f32 v45, v45
    v_exp_f32 v46, v46
    v_exp_f32 v47, v47
    s_setprio 2
    v_mfma_f32_32x32x16_bf16 v[48:63], v[96:99], v[16:19], 0
    ds_read_b128 v[96:99], v121 offset:4096
    v_mfma_f32_32x32x16_bf16 v[48:63], v[100:103], v[20:23], v[48:63]
    ds_read_b128 v[100:103], v121 offset:5120
    buffer_load_dwordx2 v[4:5], v123, s[12:15], s38 offen sc1
    s_nop 3
    s_waitcnt lgkmcnt(3)
    v_smfmac_f32_32x32x32_bf16 v[64:79], v[24:27], v[32:39], v31
    s_waitcnt lgkmcnt(2)
    v_smfmac_f32_32x32x32_bf16 v[64:79], v[112:115], v[40:47], v31
    buffer_store_dwordx4 v[252:255], v1, s[12:15], s43 offen offset:0 sc1
    s_setprio 0
    v_exp_f32 v48, v48
    s_setprio 1
    v_exp_f32 v49, v49
    v_exp_f32 v50, v50
    v_exp_f32 v51, v51
    v_exp_f32 v52, v52
    v_exp_f32 v53, v53
    v_exp_f32 v54, v54
    v_exp_f32 v55, v55
    v_exp_f32 v56, v56
    v_exp_f32 v57, v57
    v_exp_f32 v58, v58
    v_exp_f32 v59, v59
    v_exp_f32 v60, v60
    v_exp_f32 v61, v61
    v_exp_f32 v62, v62
    v_exp_f32 v63, v63
    s_setprio 2
    s_waitcnt lgkmcnt(1)
    v_mfma_f32_32x32x16_bf16 v[32:47], v[96:99], v[8:11], 0
    s_waitcnt lgkmcnt(0)
    v_mfma_f32_32x32x16_bf16 v[32:47], v[100:103], v[12:15], v[32:47]
    buffer_store_dwordx4 v[252:255], v1, s[12:15], s43 offen offset:1024 sc1
    s_nop 4
    v_smfmac_f32_32x32x32_bf16 v[80:95], v[24:27], v[48:55], v31
    ds_read_b128 v[104:107], v121 offset:6144
    s_nop 0
    v_smfmac_f32_32x32x32_bf16 v[80:95], v[112:115], v[56:63], v31
    ds_read_b128 v[108:111], v121 offset:7168
    s_setprio 0
    v_exp_f32 v32, v32
    s_setprio 1
    v_exp_f32 v33, v33
    v_exp_f32 v34, v34
    v_exp_f32 v35, v35
    v_exp_f32 v36, v36
    v_exp_f32 v37, v37
    v_exp_f32 v38, v38
    v_exp_f32 v39, v39
    v_exp_f32 v40, v40
    v_exp_f32 v41, v41
    v_exp_f32 v42, v42
    v_exp_f32 v43, v43
    v_exp_f32 v44, v44
    v_exp_f32 v45, v45
    v_exp_f32 v46, v46
    v_exp_f32 v47, v47
    s_setprio 2
    v_mfma_f32_32x32x16_bf16 v[48:63], v[96:99], v[16:19], 0
    ds_read_b128 v[96:99], v121 offset:8192
    v_mfma_f32_32x32x16_bf16 v[48:63], v[100:103], v[20:23], v[48:63]
    ds_read_b128 v[100:103], v121 offset:9216
    s_nop 4
    s_waitcnt lgkmcnt(3)
    v_smfmac_f32_32x32x32_bf16 v[64:79], v[104:107], v[32:39], v31
    s_nop 0
    s_waitcnt lgkmcnt(2)
    v_smfmac_f32_32x32x32_bf16 v[64:79], v[108:111], v[40:47], v31
    s_setprio 0
    v_exp_f32 v48, v48
    s_setprio 1
    v_exp_f32 v49, v49
    v_exp_f32 v50, v50
    v_exp_f32 v51, v51
    v_exp_f32 v52, v52
    v_exp_f32 v53, v53
    v_exp_f32 v54, v54
    v_exp_f32 v55, v55
    v_exp_f32 v56, v56
    v_exp_f32 v57, v57
    v_exp_f32 v58, v58
    v_exp_f32 v59, v59
    v_exp_f32 v60, v60
    v_exp_f32 v61, v61
    v_exp_f32 v62, v62
    v_exp_f32 v63, v63
    s_setprio 2
    s_waitcnt lgkmcnt(1)
    v_mfma_f32_32x32x16_bf16 v[32:47], v[96:99], v[8:11], 0
    s_waitcnt lgkmcnt(0)
    v_mfma_f32_32x32x16_bf16 v[32:47], v[100:103], v[12:15], v[32:47]
    s_nop 5
    v_smfmac_f32_32x32x32_bf16 v[80:95], v[104:107], v[48:55], v31
    ds_read_b128 v[24:27], v121 offset:10240
    s_nop 0
    v_smfmac_f32_32x32x32_bf16 v[80:95], v[108:111], v[56:63], v31
    ds_read_b128 v[112:115], v121 offset:11264
    s_setprio 0
    v_exp_f32 v32, v32
    s_setprio 1
    v_exp_f32 v33, v33
    v_exp_f32 v34, v34
    v_exp_f32 v35, v35
    v_exp_f32 v36, v36
    v_exp_f32 v37, v37
    v_exp_f32 v38, v38
    v_exp_f32 v39, v39
    v_exp_f32 v40, v40
    v_exp_f32 v41, v41
    v_exp_f32 v42, v42
    v_exp_f32 v43, v43
    v_exp_f32 v44, v44
    v_exp_f32 v45, v45
    v_exp_f32 v46, v46
    v_exp_f32 v47, v47
    s_setprio 2
    v_mfma_f32_32x32x16_bf16 v[48:63], v[96:99], v[16:19], 0
    ds_read_b128 v[96:99], v121 offset:12288
    v_mfma_f32_32x32x16_bf16 v[48:63], v[100:103], v[20:23], v[48:63]
    ds_read_b128 v[100:103], v121 offset:13312
    s_nop 3
    s_waitcnt lgkmcnt(3)
    v_smfmac_f32_32x32x32_bf16 v[64:79], v[24:27], v[32:39], v31
    ds_read_b128 v[104:107], v121 offset:14336
    s_waitcnt lgkmcnt(3)
    v_smfmac_f32_32x32x32_bf16 v[64:79], v[112:115], v[40:47], v31
    ds_read_b128 v[108:111], v121 offset:15360
    s_setprio 0
    v_exp_f32 v48, v48
    s_setprio 1
    v_exp_f32 v49, v49
    v_exp_f32 v50, v50
    v_exp_f32 v51, v51
    v_exp_f32 v52, v52
    v_exp_f32 v53, v53
    v_exp_f32 v54, v54
    v_exp_f32 v55, v55
    v_exp_f32 v56, v56
    v_exp_f32 v57, v57
    v_exp_f32 v58, v58
    v_exp_f32 v59, v59
    v_exp_f32 v60, v60
    v_exp_f32 v61, v61
    v_exp_f32 v62, v62
    v_exp_f32 v63, v63
    s_setprio 2
    s_waitcnt lgkmcnt(3)
    v_mfma_f32_32x32x16_bf16 v[32:47], v[96:99], v[8:11], 0
    v_cmp_eq_u64 s[74:75], v[4:5], v[126:127]
    s_and_b32 s64, s74, s42
    s_cbranch_scc0 Lslow_2
Lslow_2_ret:
    s_ff1_i32_b32 s64, s64
    s_add_u32 m0, s62, 65536
    s_bitset0_b32 s42, s64
    s_lshl_b32 s64, s64, 15
    s_add_u32 s64, s64, s68
    s_and_b32 s64, s64, 0x3ffff
    s_or_b32 s48, s64, s47
    s_waitcnt lgkmcnt(2)
    v_mfma_f32_32x32x16_bf16 v[32:47], v[100:103], v[12:15], v[32:47]
    s_nop 5
    v_smfmac_f32_32x32x32_bf16 v[80:95], v[24:27], v[48:55], v31
    v_smfmac_f32_32x32x32_bf16 v[80:95], v[112:115], v[56:63], v31
    s_setprio 0
    s_cmp_lt_u32 s56, 4
    s_waitcnt vmcnt(7) lgkmcnt(0)
    s_cbranch_scc1 Lbar_22
    s_barrier
Lbar_22:
    v_exp_f32 v32, v32
    s_setprio 1
    v_exp_f32 v33, v33
    v_exp_f32 v34, v34
    v_exp_f32 v35, v35
    v_exp_f32 v36, v36
    v_exp_f32 v37, v37
    v_exp_f32 v38, v38
    v_exp_f32 v39, v39
    v_exp_f32 v40, v40
    v_exp_f32 v41, v41
    v_exp_f32 v42, v42
    v_exp_f32 v43, v43
    v_exp_f32 v44, v44
    v_exp_f32 v45, v45
    v_exp_f32 v46, v46
    v_exp_f32 v47, v47
    s_cbranch_scc0 Lbarl_23
    s_barrier
Lbarl_23:
    s_setprio 2
    v_mfma_f32_32x32x16_bf16 v[48:63], v[96:99], v[16:19], 0
    ds_read_b128 v[96:99], v120 offset:0
    ds_read_b64_tr_b16 v[128:129], v0 offset:0
    ds_read_b64_tr_b16 v[130:131], v0 offset:1024
    v_mfma_f32_32x32x16_bf16 v[48:63], v[100:103], v[20:23], v[48:63]
    ds_read_b128 v[100:103], v120 offset:1024
    buffer_load_dwordx4 v1, s[12:15], s48 offen offset:0 sc1 lds
    ds_read_b64_tr_b16 v[132:133], v0 offset:512
    s_nop 2
    v_smfmac_f32_32x32x32_bf16 v[64:79], v[104:107], v[32:39], v31
    ds_read_b64_tr_b16 v[134:135], v0 offset:1536
    ds_read_b64_tr_b16 v[136:137], v0 offset:2048
    v_smfmac_f32_32x32x32_bf16 v[64:79], v[108:111], v[40:47], v31
    buffer_load_dwordx4 v1, s[12:15], s48 offen offset:1024 sc1 lds
    s_setprio 0
    v_exp_f32 v48, v48
    s_setprio 1
    v_exp_f32 v49, v49
    v_exp_f32 v50, v50
    v_exp_f32 v51, v51
    v_exp_f32 v52, v52
    v_exp_f32 v53, v53
    v_exp_f32 v54, v54
    v_exp_f32 v55, v55
    v_exp_f32 v56, v56
    v_exp_f32 v57, v57
    v_exp_f32 v58, v58
    v_exp_f32 v59, v59
    v_exp_f32 v60, v60
    v_exp_f32 v61, v61
    v_exp_f32 v62, v62
    v_exp_f32 v63, v63
    s_setprio 2
    s_waitcnt lgkmcnt(6)
    v_mfma_f32_32x32x16_bf16 v[32:47], v[96:99], v[8:11], 0
    ds_read_b64_tr_b16 v[138:139], v125 offset:2304
    ds_read_b64_tr_b16 v[140:141], v0 offset:2560
    s_waitcnt lgkmcnt(5)
    v_mfma_f32_32x32x16_bf16 v[32:47], v[100:103], v[12:15], v[32:47]
    buffer_load_dwordx4 v1, s[12:15], s48 offen offset:2048 sc1 lds
    ds_read_b64_tr_b16 v[142:143], v125 offset:2816
    s_nop 1
    v_smfmac_f32_32x32x32_bf16 v[80:95], v[104:107], v[48:55], v31
    ds_read_b128 v[24:27], v120 offset:2048
    ds_read_b64_tr_b16 v[144:145], v125 offset:3328
    ds_read_b64_tr_b16 v[146:147], v125 offset:4352
    v_smfmac_f32_32x32x32_bf16 v[80:95], v[108:111], v[56:63], v31
    ds_read_b128 v[112:115], v120 offset:3072
    buffer_load_dwordx4 v1, s[12:15], s48 offen offset:3072 sc1 lds
    s_setprio 0
    v_exp_f32 v32, v32
    s_setprio 1
    v_exp_f32 v33, v33
    v_exp_f32 v34, v34
    v_exp_f32 v35, v35
    v_exp_f32 v36, v36
    v_exp_f32 v37, v37
    v_exp_f32 v38, v38
    v_exp_f32 v39, v39
    v_exp_f32 v40, v40
    v_exp_f32 v41, v41
    v_exp_f32 v42, v42
    v_exp_f32 v43, v43
    v_exp_f32 v44, v44
    v_exp_f32 v45, v45
    v_exp_f32 v46, v46
    v_exp_f32 v47, v47
    s_setprio 2
    v_mfma_f32_32x32x16_bf16 v[48:63], v[96:99], v[16:19], 0
    ds_read_b128 v[96:99], v120 offset:4096
    ds_read_b64_tr_b16 v[148:149], v125 offset:3840
    ds_read_b64_tr_b16 v[150:151], v125 offset:4864
    v_mfma_f32_32x32x16_bf16 v[48:63], v[100:103], v[20:23], v[48:63]
    ds_read_b128 v[100:103], v120 offset:5120
    ds_read_b64_tr_b16 v[152:153], v125 offset:5376
    s_nop 2
    s_waitcnt lgkmcnt(8)
    v_smfmac_f32_32x32x32_bf16 v[64:79], v[24:27], v[32:39], v31
    ds_read_b64_tr_b16 v[154:155], v0 offset:6144
    ds_read_b64_tr_b16 v[156:157], v125 offset:5888
    s_waitcnt lgkmcnt(7)
    v_smfmac_f32_32x32x32_bf16 v[64:79], v[112:115], v[40:47], v31
    s_setprio 0
    v_exp_f32 v48, v48
    s_setprio 1
    v_exp_f32 v49, v49
    v_exp_f32 v50, v50
    v_exp_f32 v51, v51
    v_exp_f32 v52, v52
    v_exp_f32 v53, v53
    v_exp_f32 v54, v54
    v_exp_f32 v55, v55
    v_exp_f32 v56, v56
    v_exp_f32 v57, v57
    v_exp_f32 v58, v58
    v_exp_f32 v59, v59
    v_exp_f32 v60, v60
    v_exp_f32 v61, v61
    v_exp_f32 v62, v62
    v_exp_f32 v63, v63
    s_setprio 2
    s_waitcnt lgkmcnt(6)
    v_mfma_f32_32x32x16_bf16 v[32:47], v[96:99], v[8:11], 0
    ds_read_b64_tr_b16 v[158:159], v0 offset:6656
    ds_read_b64_tr_b16 v[160:161], v0 offset:7168
    s_waitcnt lgkmcnt(5)
    v_mfma_f32_32x32x16_bf16 v[32:47], v[100:103], v[12:15], v[32:47]
    ds_read_b64_tr_b16 v[162:163], v0 offset:8192
    s_nop 3
    v_smfmac_f32_32x32x32_bf16 v[80:95], v[24:27], v[48:55], v31
    ds_read_b128 v[104:107], v120 offset:6144
    ds_read_b64_tr_b16 v[164:165], v0 offset:7680
    ds_read_b64_tr_b16 v[166:167], v0 offset:8704
    v_smfmac_f32_32x32x32_bf16 v[80:95], v[112:115], v[56:63], v31
    ds_read_b128 v[108:111], v120 offset:7168
    s_setprio 0
    v_exp_f32 v32, v32
    s_setprio 1
    v_exp_f32 v33, v33
    v_exp_f32 v34, v34
    v_exp_f32 v35, v35
    v_exp_f32 v36, v36
    v_exp_f32 v37, v37
    v_exp_f32 v38, v38
    v_exp_f32 v39, v39
    v_exp_f32 v40, v40
    v_exp_f32 v41, v41
    v_exp_f32 v42, v42
    v_exp_f32 v43, v43
    v_exp_f32 v44, v44
    v_exp_f32 v45, v45
    v_exp_f32 v46, v46
    v_exp_f32 v47, v47
    s_setprio 2
    v_mfma_f32_32x32x16_bf16 v[48:63], v[96:99], v[16:19], 0
    ds_read_b128 v[96:99], v120 offset:8192
    ds_read_b64_tr_b16 v[168:169], v0 offset:9216
    ds_read_b64_tr_b16 v[170:171], v125 offset:9472
    v_mfma_f32_32x32x16_bf16 v[48:63], v[100:103], v[20:23], v[48:63]
    ds_read_b128 v[100:103], v120 offset:9216
    ds_read_b64_tr_b16 v[172:173], v0 offset:9728
    s_nop 2
    s_waitcnt lgkmcnt(8)
    v_smfmac_f32_32x32x32_bf16 v[64:79], v[104:107], v[32:39], v31
    ds_read_b64_tr_b16 v[174:175], v125 offset:9984
    ds_read_b64_tr_b16 v[176:177], v125 offset:10496
    s_waitcnt lgkmcnt(7)
    v_smfmac_f32_32x32x32_bf16 v[64:79], v[108:111], v[40:47], v31
    s_setprio 0
    v_exp_f32 v48, v48
    s_setprio 1
    v_exp_f32 v49, v49
    v_exp_f32 v50, v50
    v_exp_f32 v51, v51
    v_exp_f32 v52, v52
    v_exp_f32 v53, v53
    v_exp_f32 v54, v54
    v_exp_f32 v55, v55
    v_exp_f32 v56, v56
    v_exp_f32 v57, v57
    v_exp_f32 v58, v58
    v_exp_f32 v59, v59
    v_exp_f32 v60, v60
    v_exp_f32 v61, v61
    v_exp_f32 v62, v62
    v_exp_f32 v63, v63
    s_setprio 2
    s_waitcnt lgkmcnt(6)
    v_mfma_f32_32x32x16_bf16 v[32:47], v[96:99], v[8:11], 0
    ds_read_b64_tr_b16 v[178:179], v125 offset:11520
    ds_read_b64_tr_b16 v[180:181], v125 offset:11008
    s_waitcnt lgkmcnt(5)
    v_mfma_f32_32x32x16_bf16 v[32:47], v[100:103], v[12:15], v[32:47]
    ds_read_b64_tr_b16 v[182:183], v125 offset:12032
    s_nop 3
    v_smfmac_f32_32x32x32_bf16 v[80:95], v[104:107], v[48:55], v31
    ds_read_b128 v[24:27], v120 offset:10240
    ds_read_b64_tr_b16 v[184:185], v125 offset:12544
    ds_read_b64_tr_b16 v[186:187], v0 offset:13312
    v_smfmac_f32_32x32x32_bf16 v[80:95], v[108:111], v[56:63], v31
    ds_read_b128 v[112:115], v120 offset:11264
    s_setprio 0
    v_exp_f32 v32, v32
    s_setprio 1
    v_exp_f32 v33, v33
    v_exp_f32 v34, v34
    v_exp_f32 v35, v35
    v_exp_f32 v36, v36
    v_exp_f32 v37, v37
    v_exp_f32 v38, v38
    v_exp_f32 v39, v39
    v_exp_f32 v40, v40
    v_exp_f32 v41, v41
    v_exp_f32 v42, v42
    v_exp_f32 v43, v43
    v_exp_f32 v44, v44
    v_exp_f32 v45, v45
    v_exp_f32 v46, v46
    v_exp_f32 v47, v47
    s_setprio 2
    v_mfma_f32_32x32x16_bf16 v[48:63], v[96:99], v[16:19], 0
    ds_read_b128 v[96:99], v120 offset:12288
    ds_read_b64_tr_b16 v[188:189], v125 offset:13056
    ds_read_b64_tr_b16 v[190:191], v0 offset:13824
    v_mfma_f32_32x32x16_bf16 v[48:63], v[100:103], v[20:23], v[48:63]
    ds_read_b128 v[100:103], v120 offset:13312
    s_nop 3
    s_waitcnt lgkmcnt(7)
    v_smfmac_f32_32x32x32_bf16 v[64:79], v[24:27], v[32:39], v31
    ds_read_b128 v[104:107], v120 offset:14336
    s_waitcnt lgkmcnt(5)
    v_smfmac_f32_32x32x32_bf16 v[64:79], v[112:115], v[40:47], v31
    ds_read_b128 v[108:111], v120 offset:15360
    s_setprio 0
    v_exp_f32 v48, v48
    s_setprio 1
    v_exp_f32 v49, v49
    v_exp_f32 v50, v50
    v_exp_f32 v51, v51
    v_exp_f32 v52, v52
    v_exp_f32 v53, v53
    v_exp_f32 v54, v54
    v_exp_f32 v55, v55
    v_exp_f32 v56, v56
    v_exp_f32 v57, v57
    v_exp_f32 v58, v58
    v_exp_f32 v59, v59
    v_exp_f32 v60, v60
    v_exp_f32 v61, v61
    v_exp_f32 v62, v62
    v_exp_f32 v63, v63
    s_setprio 2
    s_waitcnt lgkmcnt(5)
    v_mfma_f32_32x32x16_bf16 v[32:47], v[96:99], v[8:11], 0
    s_and_b32 s64, s74, s42
    s_cbranch_scc0 Lslow_3
Lslow_3_ret:
    s_ff1_i32_b32 s64, s64
    s_add_u32 m0, s62, 0
    s_bitset0_b32 s42, s64
    s_lshl_b32 s64, s64, 15
    s_add_u32 s64, s64, s68
    s_and_b32 s64, s64, 0x3ffff
    s_or_b32 s48, s64, s47
    s_waitcnt lgkmcnt(2)
    v_mfma_f32_32x32x16_bf16 v[32:47], v[100:103], v[12:15], v[32:47]
    s_nop 5
    v_smfmac_f32_32x32x32_bf16 v[80:95], v[24:27], v[48:55], v31
    v_smfmac_f32_32x32x32_bf16 v[80:95], v[112:115], v[56:63], v31
    s_setprio 0
    s_cmp_lt_u32 s56, 4
    s_waitcnt vmcnt(4) lgkmcnt(0)
    s_cbranch_scc1 Lbar_30
    s_barrier
Lbar_30:
    v_exp_f32 v32, v32
    s_setprio 1
    v_exp_f32 v33, v33
    v_exp_f32 v34, v34
    v_exp_f32 v35, v35
    v_exp_f32 v36, v36
    v_exp_f32 v37, v37
    v_exp_f32 v38, v38
    v_exp_f32 v39, v39
    v_exp_f32 v40, v40
    v_exp_f32 v41, v41
    v_exp_f32 v42, v42
    v_exp_f32 v43, v43
    v_exp_f32 v44, v44
    v_exp_f32 v45, v45
    v_exp_f32 v46, v46
    v_exp_f32 v47, v47
    s_cbranch_scc0 Lbarl_31
    s_barrier
Lbarl_31:
    s_setprio 2
    v_mfma_f32_32x32x16_bf16 v[48:63], v[96:99], v[16:19], 0
    ds_read_b128 v[96:99], v120 offset:32768
    v_mfma_f32_32x32x16_bf16 v[48:63], v[100:103], v[20:23], v[48:63]
    ds_read_b128 v[100:103], v120 offset:33792
    buffer_load_dwordx4 v1, s[12:15], s48 offen offset:0 sc1 lds
    s_nop 3
    v_smfmac_f32_32x32x32_bf16 v[64:79], v[104:107], v[32:39], v31
    s_nop 1
    v_smfmac_f32_32x32x32_bf16 v[64:79], v[108:111], v[40:47], v31
    buffer_load_dwordx4 v1, s[12:15], s48 offen offset:1024 sc1 lds
    s_setprio 0
    v_exp_f32 v48, v48
    s_setprio 1
    v_exp_f32 v49, v49
    v_exp_f32 v50, v50
    v_exp_f32 v51, v51
    v_exp_f32 v52, v52
    v_exp_f32 v53, v53
    v_exp_f32 v54, v54
    v_exp_f32 v55, v55
    v_exp_f32 v56, v56
    v_exp_f32 v57, v57
    v_exp_f32 v58, v58
    v_exp_f32 v59, v59
    v_exp_f32 v60, v60
    v_exp_f32 v61, v61
    v_exp_f32 v62, v62
    v_exp_f32 v63, v63
    s_setprio 2
    s_waitcnt lgkmcnt(1)
    v_mfma_f32_32x32x16_bf16 v[32:47], v[96:99], v[8:11], 0
    s_waitcnt lgkmcnt(0)
    v_mfma_f32_32x32x16_bf16 v[32:47], v[100:103], v[12:15], v[32:47]
    buffer_load_dwordx4 v1, s[12:15], s48 offen offset:2048 sc1 lds
    s_nop 4
    v_smfmac_f32_32x32x32_bf16 v[80:95], v[104:107], v[48:55], v31
    ds_read_b128 v[24:27], v120 offset:34816
    v_smfmac_f32_32x32x32_bf16 v[80:95], v[108:111], v[56:63], v31
    ds_read_b128 v[112:115], v120 offset:35840
    buffer_load_dwordx4 v1, s[12:15], s48 offen offset:3072 sc1 lds
    s_setprio 0
    v_exp_f32 v32, v32
    s_setprio 1
    v_exp_f32 v33, v33
    v_exp_f32 v34, v34
    v_exp_f32 v35, v35
    v_exp_f32 v36, v36
    v_exp_f32 v37, v37
    v_exp_f32 v38, v38
    v_exp_f32 v39, v39
    v_exp_f32 v40, v40
    v_exp_f32 v41, v41
    v_exp_f32 v42, v42
    v_exp_f32 v43, v43
    v_exp_f32 v44, v44
    v_exp_f32 v45, v45
    v_exp_f32 v46, v46
    v_exp_f32 v47, v47
    s_setprio 2
    v_mfma_f32_32x32x16_bf16 v[48:63], v[96:99], v[16:19], 0
    ds_read_b128 v[96:99], v120 offset:36864
    v_mfma_f32_32x32x16_bf16 v[48:63], v[100:103], v[20:23], v[48:63]
    ds_read_b128 v[100:103], v120 offset:37888
    s_mov_b64 exec, 1
    buffer_store_dwordx2 v[126:127], v6, s[12:15], s44 offen sc1
    s_mov_b64 exec, -1
    s_waitcnt lgkmcnt(3)
    v_smfmac_f32_32x32x32_bf16 v[64:79], v[24:27], v[32:39], v31
    s_waitcnt lgkmcnt(2)
    v_smfmac_f32_32x32x32_bf16 v[64:79], v[112:115], v[40:47], v31
    s_add_u32 m0, s37, 0
    s_add_u32 s64, s79, 100352
    buffer_load_dwordx4 v124, s[20:23], s64 offen offset:0 lds
    s_setprio 0
    v_exp_f32 v48, v48
    s_setprio 1
    v_exp_f32 v49, v49
    v_exp_f32 v50, v50
    v_exp_f32 v51, v51
    v_exp_f32 v52, v52
    v_exp_f32 v53, v53
    v_exp_f32 v54, v54
    v_exp_f32 v55, v55
    v_exp_f32 v56, v56
    v_exp_f32 v57, v57
    v_exp_f32 v58, v58
    v_exp_f32 v59, v59
    v_exp_f32 v60, v60
    v_exp_f32 v61, v61
    v_exp_f32 v62, v62
    v_exp_f32 v63, v63
    s_setprio 2
    s_waitcnt lgkmcnt(1)
    v_mfma_f32_32x32x16_bf16 v[32:47], v[96:99], v[8:11], 0
    s_waitcnt lgkmcnt(0)
    v_mfma_f32_32x32x16_bf16 v[32:47], v[100:103], v[12:15], v[32:47]
    s_add_u32 s64, s79, 106496
    buffer_load_dwordx4 v124, s[20:23], s64 offen offset:1024 lds
    s_nop 2
    v_smfmac_f32_32x32x32_bf16 v[80:95], v[24:27], v[48:55], v31
    ds_read_b128 v[104:107], v120 offset:38912
    v_smfmac_f32_32x32x32_bf16 v[80:95], v[112:115], v[56:63], v31
    ds_read_b128 v[108:111], v120 offset:39936
    s_add_u32 s64, s79, 112640
    buffer_load_dwordx4 v124, s[20:23], s64 offen offset:2048 lds
    s_setprio 0
    v_exp_f32 v32, v32
    s_setprio 1
    v_exp_f32 v33, v33
    v_exp_f32 v34, v34
    v_exp_f32 v35, v35
    v_exp_f32 v36, v36
    v_exp_f32 v37, v37
    v_exp_f32 v38, v38
    v_exp_f32 v39, v39
    v_exp_f32 v40, v40
    v_exp_f32 v41, v41
    v_exp_f32 v42, v42
    v_exp_f32 v43, v43
    v_exp_f32 v44, v44
    v_exp_f32 v45, v45
    v_exp_f32 v46, v46
    v_exp_f32 v47, v47
    s_setprio 2
    v_mfma_f32_32x32x16_bf16 v[48:63], v[96:99], v[16:19], 0
    ds_read_b128 v[96:99], v120 offset:40960
    v_mfma_f32_32x32x16_bf16 v[48:63], v[100:103], v[20:23], v[48:63]
    ds_read_b128 v[100:103], v120 offset:41984
    s_add_u32 s64, s79, 118784
    buffer_load_dwordx4 v124, s[20:23], s64 offen offset:3072 lds
    s_nop 0
    s_waitcnt lgkmcnt(3)
    v_smfmac_f32_32x32x32_bf16 v[64:79], v[104:107], v[32:39], v31
    s_waitcnt lgkmcnt(2)
    v_smfmac_f32_32x32x32_bf16 v[64:79], v[108:111], v[40:47], v31
    s_add_u32 m0, s37, 4096
    s_add_u32 s64, s79, 129024
    buffer_load_dwordx4 v124, s[20:23], s64 offen offset:0 lds
    s_setprio 0
    v_exp_f32 v48, v48
    s_setprio 1
    v_exp_f32 v49, v49
    v_exp_f32 v50, v50
    v_exp_f32 v51, v51
    v_exp_f32 v52, v52
    v_exp_f32 v53, v53
    v_exp_f32 v54, v54
    v_exp_f32 v55, v55
    v_exp_f32 v56, v56
    v_exp_f32 v57, v57
    v_exp_f32 v58, v58
    v_exp_f32 v59, v59
    v_exp_f32 v60, v60
    v_exp_f32 v61, v61
    v_exp_f32 v62, v62
    v_exp_f32 v63, v63
    s_setprio 2
    s_waitcnt lgkmcnt(1)
    v_mfma_f32_32x32x16_bf16 v[32:47], v[96:99], v[8:11], 0
    s_waitcnt lgkmcnt(0)
    v_mfma_f32_32x32x16_bf16 v[32:47], v[100:103], v[12:15], v[32:47]
    s_add_u32 s64, s79, 135168
    buffer_load_dwordx4 v124, s[20:23], s64 offen offset:1024 lds
    s_nop 2
    v_smfmac_f32_32x32x32_bf16 v[80:95], v[104:107], v[48:55], v31
    ds_read_b128 v[24:27], v120 offset:43008
    v_smfmac_f32_32x32x32_bf16 v[80:95], v[108:111], v[56:63], v31
    ds_read_b128 v[112:115], v120 offset:44032
    s_add_u32 s64, s79, 141312
    buffer_load_dwordx4 v124, s[20:23], s64 offen offset:2048 lds
    s_setprio 0
    v_exp_f32 v32, v32
    s_setprio 1
    v_exp_f32 v33, v33
    v_exp_f32 v34, v34
    v_exp_f32 v35, v35
    v_exp_f32 v36, v36
    v_exp_f32 v37, v37
    v_exp_f32 v38, v38
    v_exp_f32 v39, v39
    v_exp_f32 v40, v40
    v_exp_f32 v41, v41
    v_exp_f32 v42, v42
    v_exp_f32 v43, v43
    v_exp_f32 v44, v44
    v_exp_f32 v45, v45
    v_exp_f32 v46, v46
    v_exp_f32 v47, v47
    s_setprio 2
    v_mfma_f32_32x32x16_bf16 v[48:63], v[96:99], v[16:19], 0
    ds_read_b128 v[96:99], v120 offset:45056
    v_mfma_f32_32x32x16_bf16 v[48:63], v[100:103], v[20:23], v[48:63]
    ds_read_b128 v[100:103], v120 offset:46080
    s_nop 3
    s_waitcnt lgkmcnt(3)
    v_smfmac_f32_32x32x32_bf16 v[64:79], v[24:27], v[32:39], v31
    ds_read_b128 v[104:107], v120 offset:47104
    s_waitcnt lgkmcnt(3)
    v_smfmac_f32_32x32x32_bf16 v[64:79], v[112:115], v[40:47], v31
    ds_read_b128 v[108:111], v120 offset:48128
    s_setprio 0
    v_exp_f32 v48, v48
    s_setprio 1
    v_exp_f32 v49, v49
    v_exp_f32 v50, v50
    v_exp_f32 v51, v51
    v_exp_f32 v52, v52
    v_exp_f32 v53, v53
    v_exp_f32 v54, v54
    v_exp_f32 v55, v55
    v_exp_f32 v56, v56
    v_exp_f32 v57, v57
    v_exp_f32 v58, v58
    v_exp_f32 v59, v59
    v_exp_f32 v60, v60
    v_exp_f32 v61, v61
    v_exp_f32 v62, v62
    v_exp_f32 v63, v63
    s_setprio 2
    s_waitcnt lgkmcnt(3)
    v_mfma_f32_32x32x16_bf16 v[32:47], v[96:99], v[8:11], 0
    s_and_b32 s64, s74, s42
    s_cbranch_scc0 Lslow_4
Lslow_4_ret:
    s_ff1_i32_b32 s64, s64
    s_add_u32 m0, s62, 32768
    s_bitset0_b32 s42, s64
    s_lshl_b32 s64, s64, 15
    s_add_u32 s64, s64, s68
    s_and_b32 s64, s64, 0x3ffff
    s_or_b32 s48, s64, s47
    s_waitcnt lgkmcnt(2)
    v_mfma_f32_32x32x16_bf16 v[32:47], v[100:103], v[12:15], v[32:47]
    s_nop 5
    v_smfmac_f32_32x32x32_bf16 v[80:95], v[24:27], v[48:55], v31
    v_smfmac_f32_32x32x32_bf16 v[80:95], v[112:115], v[56:63], v31
    s_setprio 0
    s_cmp_lt_u32 s56, 4
    s_waitcnt vmcnt(12) lgkmcnt(0)
    s_cbranch_scc1 Lbar_38
    s_barrier
Lbar_38:
    v_exp_f32 v32, v32
    s_setprio 1
    v_exp_f32 v33, v33
    v_exp_f32 v34, v34
    v_exp_f32 v35, v35
    v_exp_f32 v36, v36
    v_exp_f32 v37, v37
    v_exp_f32 v38, v38
    v_exp_f32 v39, v39
    v_exp_f32 v40, v40
    v_exp_f32 v41, v41
    v_exp_f32 v42, v42
    v_exp_f32 v43, v43
    v_exp_f32 v44, v44
    v_exp_f32 v45, v45
    v_exp_f32 v46, v46
    v_exp_f32 v47, v47
    s_cbranch_scc0 Lbarl_39
    s_barrier
Lbarl_39:
    s_setprio 2
    v_mfma_f32_32x32x16_bf16 v[48:63], v[96:99], v[16:19], 0
    ds_read_b128 v[96:99], v121 offset:0
    v_mfma_f32_32x32x16_bf16 v[48:63], v[100:103], v[20:23], v[48:63]
    ds_read_b128 v[100:103], v121 offset:1024
    buffer_load_dwordx4 v1, s[12:15], s48 offen offset:0 sc1 lds
    s_nop 3
    v_smfmac_f32_32x32x32_bf16 v[64:79], v[104:107], v[32:39], v31
    s_nop 1
    v_smfmac_f32_32x32x32_bf16 v[64:79], v[108:111], v[40:47], v31
    buffer_load_dwordx4 v1, s[12:15], s48 offen offset:1024 sc1 lds
    s_setprio 0
    v_exp_f32 v48, v48
    s_setprio 1
    v_exp_f32 v49, v49
    v_exp_f32 v50, v50
    v_exp_f32 v51, v51
    v_exp_f32 v52, v52
    v_exp_f32 v53, v53
    v_exp_f32 v54, v54
    v_exp_f32 v55, v55
    v_exp_f32 v56, v56
    v_exp_f32 v57, v57
    v_exp_f32 v58, v58
    v_exp_f32 v59, v59
    v_exp_f32 v60, v60
    v_exp_f32 v61, v61
    v_exp_f32 v62, v62
    v_exp_f32 v63, v63
    s_setprio 2
    s_waitcnt lgkmcnt(1)
    v_mfma_f32_32x32x16_bf16 v[32:47], v[96:99], v[8:11], 0
    s_waitcnt lgkmcnt(0)
    v_mfma_f32_32x32x16_bf16 v[32:47], v[100:103], v[12:15], v[32:47]
    buffer_load_dwordx4 v1, s[12:15], s48 offen offset:2048 sc1 lds
    s_nop 4
    v_smfmac_f32_32x32x32_bf16 v[80:95], v[104:107], v[48:55], v31
    ds_read_b128 v[24:27], v121 offset:2048
    v_smfmac_f32_32x32x32_bf16 v[80:95], v[108:111], v[56:63], v31
    ds_read_b128 v[112:115], v121 offset:3072
    buffer_load_dwordx4 v1, s[12:15], s48 offen offset:3072 sc1 lds
    s_setprio 0
    v_exp_f32 v32, v32
    s_setprio 1
    v_exp_f32 v33, v33
    v_exp_f32 v34, v34
    v_exp_f32 v35, v35
    v_exp_f32 v36, v36
    v_exp_f32 v37, v37
    v_exp_f32 v38, v38
    v_exp_f32 v39, v39
    v_exp_f32 v40, v40
    v_exp_f32 v41, v41
    v_exp_f32 v42, v42
    v_exp_f32 v43, v43
    v_exp_f32 v44, v44
    v_exp_f32 v45, v45
    v_exp_f32 v46, v46
    v_exp_f32 v47, v47
    s_setprio 2
    v_mfma_f32_32x32x16_bf16 v[48:63], v[96:99], v[16:19], 0
    ds_read_b128 v[96:99], v121 offset:4096
    v_mfma_f32_32x32x16_bf16 v[48:63], v[100:103], v[20:23], v[48:63]
    ds_read_b128 v[100:103], v121 offset:5120
    s_nop 4
    s_waitcnt lgkmcnt(3)
    v_smfmac_f32_32x32x32_bf16 v[64:79], v[24:27], v[32:39], v31
    s_nop 0
    s_waitcnt lgkmcnt(2)
    v_smfmac_f32_32x32x32_bf16 v[64:79], v[112:115], v[40:47], v31
    s_setprio 0
    v_exp_f32 v48, v48
    s_setprio 1
    v_exp_f32 v49, v49
    v_exp_f32 v50, v50
    v_exp_f32 v51, v51
    v_exp_f32 v52, v52
    v_exp_f32 v53, v53
    v_exp_f32 v54, v54
    v_exp_f32 v55, v55
    v_exp_f32 v56, v56
    v_exp_f32 v57, v57
    v_exp_f32 v58, v58
    v_exp_f32 v59, v59
    v_exp_f32 v60, v60
    v_exp_f32 v61, v61
    v_exp_f32 v62, v62
    v_exp_f32 v63, v63
    s_setprio 2
    s_waitcnt lgkmcnt(1)
    v_mfma_f32_32x32x16_bf16 v[32:47], v[96:99], v[8:11], 0
    s_waitcnt lgkmcnt(0)
    v_mfma_f32_32x32x16_bf16 v[32:47], v[100:103], v[12:15], v[32:47]
    s_nop 5
    v_smfmac_f32_32x32x32_bf16 v[80:95], v[24:27], v[48:55], v31
    ds_read_b128 v[104:107], v121 offset:6144
    s_nop 0
    v_smfmac_f32_32x32x32_bf16 v[80:95], v[112:115], v[56:63], v31
    ds_read_b128 v[108:111], v121 offset:7168
    s_setprio 0
    v_exp_f32 v32, v32
    s_setprio 1
    v_exp_f32 v33, v33
    v_exp_f32 v34, v34
    v_exp_f32 v35, v35
    v_exp_f32 v36, v36
    v_exp_f32 v37, v37
    v_exp_f32 v38, v38
    v_exp_f32 v39, v39
    v_exp_f32 v40, v40
    v_exp_f32 v41, v41
    v_exp_f32 v42, v42
    v_exp_f32 v43, v43
    v_exp_f32 v44, v44
    v_exp_f32 v45, v45
    v_exp_f32 v46, v46
    v_exp_f32 v47, v47
    s_setprio 2
    v_mfma_f32_32x32x16_bf16 v[48:63], v[96:99], v[16:19], 0
    ds_read_b128 v[96:99], v121 offset:8192
    v_mfma_f32_32x32x16_bf16 v[48:63], v[100:103], v[20:23], v[48:63]
    ds_read_b128 v[100:103], v121 offset:9216
    s_nop 4
    s_waitcnt lgkmcnt(3)
    v_smfmac_f32_32x32x32_bf16 v[64:79], v[104:107], v[32:39], v31
    s_nop 0
    s_waitcnt lgkmcnt(2)
    v_smfmac_f32_32x32x32_bf16 v[64:79], v[108:111], v[40:47], v31
    s_setprio 0
    v_exp_f32 v48, v48
    s_setprio 1
    v_exp_f32 v49, v49
    v_exp_f32 v50, v50
    v_exp_f32 v51, v51
    v_exp_f32 v52, v52
    v_exp_f32 v53, v53
    v_exp_f32 v54, v54
    v_exp_f32 v55, v55
    v_exp_f32 v56, v56
    v_exp_f32 v57, v57
    v_exp_f32 v58, v58
    v_exp_f32 v59, v59
    v_exp_f32 v60, v60
    v_exp_f32 v61, v61
    v_exp_f32 v62, v62
    v_exp_f32 v63, v63
    s_setprio 2
    s_waitcnt lgkmcnt(1)
    v_mfma_f32_32x32x16_bf16 v[32:47], v[96:99], v[8:11], 0
    s_waitcnt lgkmcnt(0)
    v_mfma_f32_32x32x16_bf16 v[32:47], v[100:103], v[12:15], v[32:47]
    s_nop 5
    v_smfmac_f32_32x32x32_bf16 v[80:95], v[104:107], v[48:55], v31
    ds_read_b128 v[24:27], v121 offset:10240
    s_nop 0
    v_smfmac_f32_32x32x32_bf16 v[80:95], v[108:111], v[56:63], v31
    ds_read_b128 v[112:115], v121 offset:11264
    s_setprio 0
    v_exp_f32 v32, v32
    s_setprio 1
    v_exp_f32 v33, v33
    v_exp_f32 v34, v34
    v_exp_f32 v35, v35
    v_exp_f32 v36, v36
    v_exp_f32 v37, v37
    v_exp_f32 v38, v38
    v_exp_f32 v39, v39
    v_exp_f32 v40, v40
    v_exp_f32 v41, v41
    v_exp_f32 v42, v42
    v_exp_f32 v43, v43
    v_exp_f32 v44, v44
    v_exp_f32 v45, v45
    v_exp_f32 v46, v46
    v_exp_f32 v47, v47
    s_setprio 2
    v_mfma_f32_32x32x16_bf16 v[48:63], v[96:99], v[16:19], 0
    ds_read_b128 v[96:99], v121 offset:12288
    v_mfma_f32_32x32x16_bf16 v[48:63], v[100:103], v[20:23], v[48:63]
    ds_read_b128 v[100:103], v121 offset:13312
    s_nop 3
    s_waitcnt lgkmcnt(3)
    v_smfmac_f32_32x32x32_bf16 v[64:79], v[24:27], v[32:39], v31
    ds_read_b128 v[104:107], v121 offset:14336
    s_waitcnt lgkmcnt(3)
    v_smfmac_f32_32x32x32_bf16 v[64:79], v[112:115], v[40:47], v31
    ds_read_b128 v[108:111], v121 offset:15360
    s_setprio 0
    v_exp_f32 v48, v48
    s_setprio 1
    v_exp_f32 v49, v49
    v_exp_f32 v50, v50
    v_exp_f32 v51, v51
    v_exp_f32 v52, v52
    v_exp_f32 v53, v53
    v_exp_f32 v54, v54
    v_exp_f32 v55, v55
    v_exp_f32 v56, v56
    v_exp_f32 v57, v57
    v_exp_f32 v58, v58
    v_exp_f32 v59, v59
    v_exp_f32 v60, v60
    v_exp_f32 v61, v61
    v_exp_f32 v62, v62
    v_exp_f32 v63, v63
    s_setprio 2
    s_waitcnt lgkmcnt(3)
    v_mfma_f32_32x32x16_bf16 v[32:47], v[96:99], v[8:11], 0
    s_waitcnt lgkmcnt(2)
    v_mfma_f32_32x32x16_bf16 v[32:47], v[100:103], v[12:15], v[32:47]
    s_nop 5
    v_smfmac_f32_32x32x32_bf16 v[80:95], v[24:27], v[48:55], v31
    v_smfmac_f32_32x32x32_bf16 v[80:95], v[112:115], v[56:63], v31
    s_setprio 0
    s_cmp_lt_u32 s56, 4
    s_waitcnt vmcnt(4) lgkmcnt(0)
    s_cbranch_scc1 Lbar_46
    s_barrier
Lbar_46:
    v_exp_f32 v32, v32
    s_setprio 1
    v_exp_f32 v33, v33
    v_exp_f32 v34, v34
    v_exp_f32 v35, v35
    v_exp_f32 v36, v36
    v_exp_f32 v37, v37
    v_exp_f32 v38, v38
    v_exp_f32 v39, v39
    v_exp_f32 v40, v40
    v_exp_f32 v41, v41
    v_exp_f32 v42, v42
    v_exp_f32 v43, v43
    v_exp_f32 v44, v44
    v_exp_f32 v45, v45
    v_exp_f32 v46, v46
    v_exp_f32 v47, v47
    s_cbranch_scc0 Lbarl_47
    s_barrier
Lbarl_47:
    s_setprio 2
    v_mfma_f32_32x32x16_bf16 v[48:63], v[96:99], v[16:19], 0
    ds_read_b128 v[96:99], v120 offset:0
    v_lshrrev_b32 v122, 8, v3
    ds_read_b64_tr_b16 v[192:193], v0 offset:0
    ds_read_b64_tr_b16 v[194:195], v0 offset:1024
    v_mfma_f32_32x32x16_bf16 v[48:63], v[100:103], v[20:23], v[48:63]
    ds_read_b128 v[100:103], v120 offset:1024
    ds_read_b64_tr_b16 v[196:197], v0 offset:512
    s_nop 3
    v_smfmac_f32_32x32x32_bf16 v[64:79], v[104:107], v[32:39], v31
    ds_read_b64_tr_b16 v[198:199], v0 offset:1536
    ds_read_b64_tr_b16 v[200:201], v0 offset:2048
    s_nop 0
    v_smfmac_f32_32x32x32_bf16 v[64:79], v[108:111], v[40:47], v31
    s_setprio 0
    v_exp_f32 v48, v48
    s_setprio 1
    v_exp_f32 v49, v49
    v_exp_f32 v50, v50
    v_exp_f32 v51, v51
    v_exp_f32 v52, v52
    v_exp_f32 v53, v53
    v_exp_f32 v54, v54
    v_exp_f32 v55, v55
    v_exp_f32 v56, v56
    v_exp_f32 v57, v57
    v_exp_f32 v58, v58
    v_exp_f32 v59, v59
    v_exp_f32 v60, v60
    v_exp_f32 v61, v61
    v_exp_f32 v62, v62
    v_exp_f32 v63, v63
    s_setprio 2
    s_waitcnt lgkmcnt(6)
    v_mfma_f32_32x32x16_bf16 v[32:47], v[96:99], v[8:11], 0
    ds_read_b64_tr_b16 v[202:203], v125 offset:2304
    ds_read_b64_tr_b16 v[204:205], v0 offset:2560
    s_waitcnt lgkmcnt(5)
    v_mfma_f32_32x32x16_bf16 v[32:47], v[100:103], v[12:15], v[32:47]
    ds_read_b64_tr_b16 v[206:207], v125 offset:2816
    s_nop 3
    v_smfmac_f32_32x32x32_bf16 v[80:95], v[104:107], v[48:55], v31
    ds_read_b128 v[24:27], v120 offset:2048
    ds_read_b64_tr_b16 v[208:209], v125 offset:3328
    ds_read_b64_tr_b16 v[210:211], v125 offset:4352
    v_smfmac_f32_32x32x32_bf16 v[80:95], v[108:111], v[56:63], v31
    ds_read_b128 v[112:115], v120 offset:3072
    s_setprio 0
    v_exp_f32 v32, v32
    s_setprio 1
    v_exp_f32 v33, v33
    v_exp_f32 v34, v34
    v_exp_f32 v35, v35
    v_exp_f32 v36, v36
    v_exp_f32 v37, v37
    v_exp_f32 v38, v38
    v_exp_f32 v39, v39
    v_exp_f32 v40, v40
    v_exp_f32 v41, v41
    v_exp_f32 v42, v42
    v_exp_f32 v43, v43
    v_exp_f32 v44, v44
    v_exp_f32 v45, v45
    v_exp_f32 v46, v46
    v_exp_f32 v47, v47
    s_setprio 2
    v_mfma_f32_32x32x16_bf16 v[48:63], v[96:99], v[16:19], 0
    ds_read_b128 v[96:99], v120 offset:4096
    ds_read_b64_tr_b16 v[212:213], v125 offset:3840
    ds_read_b64_tr_b16 v[214:215], v125 offset:4864
    v_mfma_f32_32x32x16_bf16 v[48:63], v[100:103], v[20:23], v[48:63]
    ds_read_b128 v[100:103], v120 offset:5120
    ds_read_b64_tr_b16 v[216:217], v125 offset:5376
    s_nop 2
    s_waitcnt lgkmcnt(8)
    v_smfmac_f32_32x32x32_bf16 v[64:79], v[24:27], v[32:39], v31
    ds_read_b64_tr_b16 v[218:219], v0 offset:6144
    ds_read_b64_tr_b16 v[220:221], v125 offset:5888
    s_waitcnt lgkmcnt(7)
    v_smfmac_f32_32x32x32_bf16 v[64:79], v[112:115], v[40:47], v31
    s_setprio 0
    v_exp_f32 v48, v48
    s_setprio 1
    v_exp_f32 v49, v49
    v_exp_f32 v50, v50
    v_exp_f32 v51, v51
    v_exp_f32 v52, v52
    v_exp_f32 v53, v53
    v_exp_f32 v54, v54
    v_exp_f32 v55, v55
    v_exp_f32 v56, v56
    v_exp_f32 v57, v57
    v_exp_f32 v58, v58
    v_exp_f32 v59, v59
    v_exp_f32 v60, v60
    v_exp_f32 v61, v61
    v_exp_f32 v62, v62
    v_exp_f32 v63, v63
    s_setprio 2
    s_waitcnt lgkmcnt(6)
    v_mfma_f32_32x32x16_bf16 v[32:47], v[96:99], v[8:11], 0
    ds_read_b64_tr_b16 v[222:223], v0 offset:6656
    ds_read_b64_tr_b16 v[224:225], v0 offset:7168
    s_waitcnt lgkmcnt(5)
    v_mfma_f32_32x32x16_bf16 v[32:47], v[100:103], v[12:15], v[32:47]
    ds_read_b64_tr_b16 v[226:227], v0 offset:8192
    s_nop 3
    v_smfmac_f32_32x32x32_bf16 v[80:95], v[24:27], v[48:55], v31
    ds_read_b128 v[104:107], v120 offset:6144
    ds_read_b64_tr_b16 v[228:229], v0 offset:7680
    ds_read_b64_tr_b16 v[230:231], v0 offset:8704
    v_smfmac_f32_32x32x32_bf16 v[80:95], v[112:115], v[56:63], v31
    ds_read_b128 v[108:111], v120 offset:7168
    s_setprio 0
    v_exp_f32 v32, v32
    s_setprio 1
    v_exp_f32 v33, v33
    v_exp_f32 v34, v34
    v_exp_f32 v35, v35
    v_exp_f32 v36, v36
    v_exp_f32 v37, v37
    v_exp_f32 v38, v38
    v_exp_f32 v39, v39
    v_exp_f32 v40, v40
    v_exp_f32 v41, v41
    v_exp_f32 v42, v42
    v_exp_f32 v43, v43
    v_exp_f32 v44, v44
    v_exp_f32 v45, v45
    v_exp_f32 v46, v46
    v_exp_f32 v47, v47
    s_setprio 2
    v_mfma_f32_32x32x16_bf16 v[48:63], v[96:99], v[16:19], 0
    ds_read_b128 v[96:99], v120 offset:8192
    ds_read_b64_tr_b16 v[232:233], v0 offset:9216
    ds_read_b64_tr_b16 v[234:235], v125 offset:9472
    v_mfma_f32_32x32x16_bf16 v[48:63], v[100:103], v[20:23], v[48:63]
    ds_read_b128 v[100:103], v120 offset:9216
    ds_read_b64_tr_b16 v[236:237], v0 offset:9728
    s_nop 2
    s_waitcnt lgkmcnt(8)
    v_smfmac_f32_32x32x32_bf16 v[64:79], v[104:107], v[32:39], v31
    ds_read_b64_tr_b16 v[238:239], v125 offset:9984
    ds_read_b64_tr_b16 v[240:241], v125 offset:10496
    s_waitcnt lgkmcnt(7)
    v_smfmac_f32_32x32x32_bf16 v[64:79], v[108:111], v[40:47], v31
    s_setprio 0
    v_exp_f32 v48, v48
    s_setprio 1
    v_exp_f32 v49, v49
    v_exp_f32 v50, v50
    v_exp_f32 v51, v51
    v_exp_f32 v52, v52
    v_exp_f32 v53, v53
    v_exp_f32 v54, v54
    v_exp_f32 v55, v55
    v_exp_f32 v56, v56
    v_exp_f32 v57, v57
    v_exp_f32 v58, v58
    v_exp_f32 v59, v59
    v_exp_f32 v60, v60
    v_exp_f32 v61, v61
    v_exp_f32 v62, v62
    v_exp_f32 v63, v63
    s_setprio 2
    s_waitcnt lgkmcnt(6)
    v_mfma_f32_32x32x16_bf16 v[32:47], v[96:99], v[8:11], 0
    ds_read_b64_tr_b16 v[242:243], v125 offset:11520
    ds_read_b64_tr_b16 v[244:245], v125 offset:11008
    s_waitcnt lgkmcnt(5)
    v_mfma_f32_32x32x16_bf16 v[32:47], v[100:103], v[12:15], v[32:47]
    ds_read_b64_tr_b16 v[246:247], v125 offset:12032
    s_nop 3
    v_smfmac_f32_32x32x32_bf16 v[80:95], v[104:107], v[48:55], v31
    ds_read_b128 v[24:27], v120 offset:10240
    ds_read_b64_tr_b16 v[248:249], v125 offset:12544
    ds_read_b64_tr_b16 v[250:251], v0 offset:13312
    v_smfmac_f32_32x32x32_bf16 v[80:95], v[108:111], v[56:63], v31
    ds_read_b128 v[112:115], v120 offset:11264
    s_setprio 0
    v_exp_f32 v32, v32
    s_setprio 1
    v_exp_f32 v33, v33
    v_exp_f32 v34, v34
    v_exp_f32 v35, v35
    v_exp_f32 v36, v36
    v_exp_f32 v37, v37
    v_exp_f32 v38, v38
    v_exp_f32 v39, v39
    v_exp_f32 v40, v40
    v_exp_f32 v41, v41
    v_exp_f32 v42, v42
    v_exp_f32 v43, v43
    v_exp_f32 v44, v44
    v_exp_f32 v45, v45
    v_exp_f32 v46, v46
    v_exp_f32 v47, v47
    s_setprio 2
    v_mfma_f32_32x32x16_bf16 v[48:63], v[96:99], v[16:19], 0
    ds_read_b128 v[96:99], v120 offset:12288
    ds_read_b64_tr_b16 v[252:253], v125 offset:13056
    ds_read_b64_tr_b16 v[254:255], v0 offset:13824
    v_mfma_f32_32x32x16_bf16 v[48:63], v[100:103], v[20:23], v[48:63]
    ds_read_b128 v[100:103], v120 offset:13312
    s_nop 3
    s_waitcnt lgkmcnt(7)
    v_smfmac_f32_32x32x32_bf16 v[64:79], v[24:27], v[32:39], v31
    ds_read_b128 v[104:107], v120 offset:14336
    s_waitcnt lgkmcnt(5)
    v_smfmac_f32_32x32x32_bf16 v[64:79], v[112:115], v[40:47], v31
    ds_read_b128 v[108:111], v120 offset:15360
    s_setprio 0
    v_exp_f32 v48, v48
    s_setprio 1
    v_exp_f32 v49, v49
    v_exp_f32 v50, v50
    v_exp_f32 v51, v51
    v_exp_f32 v52, v52
    v_exp_f32 v53, v53
    v_exp_f32 v54, v54
    v_exp_f32 v55, v55
    v_exp_f32 v56, v56
    v_exp_f32 v57, v57
    v_exp_f32 v58, v58
    v_exp_f32 v59, v59
    v_exp_f32 v60, v60
    v_exp_f32 v61, v61
    v_exp_f32 v62, v62
    v_exp_f32 v63, v63
    s_setprio 2
    s_waitcnt lgkmcnt(5)
    v_mfma_f32_32x32x16_bf16 v[32:47], v[96:99], v[8:11], 0
    s_waitcnt lgkmcnt(2)
    v_mfma_f32_32x32x16_bf16 v[32:47], v[100:103], v[12:15], v[32:47]
    s_nop 5
    v_smfmac_f32_32x32x32_bf16 v[80:95], v[24:27], v[48:55], v31
    v_smfmac_f32_32x32x32_bf16 v[80:95], v[112:115], v[56:63], v31
    s_setprio 0
    s_cmp_lt_u32 s56, 4
    s_waitcnt vmcnt(0) lgkmcnt(0)
    s_cbranch_scc1 Lbar_54
    s_barrier
Lbar_54:
    v_exp_f32 v32, v32
    s_setprio 1
    v_exp_f32 v33, v33
    v_exp_f32 v34, v34
    v_exp_f32 v35, v35
    v_exp_f32 v36, v36
    v_exp_f32 v37, v37
    v_exp_f32 v38, v38
    v_exp_f32 v39, v39
    v_exp_f32 v40, v40
    v_exp_f32 v41, v41
    v_exp_f32 v42, v42
    v_exp_f32 v43, v43
    v_exp_f32 v44, v44
    v_exp_f32 v45, v45
    v_exp_f32 v46, v46
    v_exp_f32 v47, v47
    s_cbranch_scc0 Lbarl_55
    s_barrier
Lbarl_55:
    s_setprio 2
    v_mfma_f32_32x32x16_bf16 v[48:63], v[96:99], v[16:19], 0
    ds_read_b128 v[96:99], v120 offset:32768
    v_mfma_f32_32x32x16_bf16 v[48:63], v[100:103], v[20:23], v[48:63]
    ds_read_b128 v[100:103], v120 offset:33792
    buffer_load_dwordx2 v[4:5], v122, s[12:15], s45 offen sc1
    s_nop 3
    v_smfmac_f32_32x32x32_bf16 v[64:79], v[104:107], v[32:39], v31
    s_nop 2
    v_smfmac_f32_32x32x32_bf16 v[64:79], v[108:111], v[40:47], v31
    s_setprio 0
    v_exp_f32 v48, v48
    s_setprio 1
    v_exp_f32 v49, v49
    v_exp_f32 v50, v50
    v_exp_f32 v51, v51
    v_exp_f32 v52, v52
    v_exp_f32 v53, v53
    v_exp_f32 v54, v54
    v_exp_f32 v55, v55
    v_exp_f32 v56, v56
    v_exp_f32 v57, v57
    v_exp_f32 v58, v58
    v_exp_f32 v59, v59
    v_exp_f32 v60, v60
    v_exp_f32 v61, v61
    v_exp_f32 v62, v62
    v_exp_f32 v63, v63
    s_setprio 2
    s_waitcnt lgkmcnt(1)
    v_mfma_f32_32x32x16_bf16 v[32:47], v[96:99], v[8:11], 0
    s_waitcnt lgkmcnt(0)
    v_mfma_f32_32x32x16_bf16 v[32:47], v[100:103], v[12:15], v[32:47]
    s_nop 5
    v_smfmac_f32_32x32x32_bf16 v[80:95], v[104:107], v[48:55], v31
    ds_read_b128 v[24:27], v120 offset:34816
    s_nop 0
    v_smfmac_f32_32x32x32_bf16 v[80:95], v[108:111], v[56:63], v31
    ds_read_b128 v[112:115], v120 offset:35840
    s_setprio 0
    v_exp_f32 v32, v32
    s_setprio 1
    v_exp_f32 v33, v33
    v_exp_f32 v34, v34
    v_exp_f32 v35, v35
    v_exp_f32 v36, v36
    v_exp_f32 v37, v37
    v_exp_f32 v38, v38
    v_exp_f32 v39, v39
    v_exp_f32 v40, v40
    v_exp_f32 v41, v41
    v_exp_f32 v42, v42
    v_exp_f32 v43, v43
    v_exp_f32 v44, v44
    v_exp_f32 v45, v45
    v_exp_f32 v46, v46
    v_exp_f32 v47, v47
    s_setprio 2
    v_mfma_f32_32x32x16_bf16 v[48:63], v[96:99], v[16:19], 0
    ds_read_b128 v[96:99], v120 offset:36864
    v_mfma_f32_32x32x16_bf16 v[48:63], v[100:103], v[20:23], v[48:63]
    ds_read_b128 v[100:103], v120 offset:37888
    s_nop 4
    s_waitcnt lgkmcnt(3)
    v_smfmac_f32_32x32x32_bf16 v[64:79], v[24:27], v[32:39], v31
    s_nop 0
    s_waitcnt lgkmcnt(2)
    v_smfmac_f32_32x32x32_bf16 v[64:79], v[112:115], v[40:47], v31
    s_setprio 0
    v_exp_f32 v48, v48
    s_setprio 1
    v_exp_f32 v49, v49
    v_exp_f32 v50, v50
    v_exp_f32 v51, v51
    v_exp_f32 v52, v52
    v_exp_f32 v53, v53
    v_exp_f32 v54, v54
    v_exp_f32 v55, v55
    v_exp_f32 v56, v56
    v_exp_f32 v57, v57
    v_exp_f32 v58, v58
    v_exp_f32 v59, v59
    v_exp_f32 v60, v60
    v_exp_f32 v61, v61
    v_exp_f32 v62, v62
    v_exp_f32 v63, v63
    s_setprio 2
    s_waitcnt lgkmcnt(1)
    v_mfma_f32_32x32x16_bf16 v[32:47], v[96:99], v[8:11], 0
    s_waitcnt lgkmcnt(0)
    v_mfma_f32_32x32x16_bf16 v[32:47], v[100:103], v[12:15], v[32:47]
    s_nop 5
    v_smfmac_f32_32x32x32_bf16 v[80:95], v[24:27], v[48:55], v31
    ds_read_b128 v[104:107], v120 offset:38912
    s_nop 0
    v_smfmac_f32_32x32x32_bf16 v[80:95], v[112:115], v[56:63], v31
    ds_read_b128 v[108:111], v120 offset:39936
    s_setprio 0
    v_exp_f32 v32, v32
    s_setprio 1
    v_exp_f32 v33, v33
    v_exp_f32 v34, v34
    v_exp_f32 v35, v35
    v_exp_f32 v36, v36
    v_exp_f32 v37, v37
    v_exp_f32 v38, v38
    v_exp_f32 v39, v39
    v_exp_f32 v40, v40
    v_exp_f32 v41, v41
    v_exp_f32 v42, v42
    v_exp_f32 v43, v43
    v_exp_f32 v44, v44
    v_exp_f32 v45, v45
    v_exp_f32 v46, v46
    v_exp_f32 v47, v47
    s_setprio 2
    v_mfma_f32_32x32x16_bf16 v[48:63], v[96:99], v[16:19], 0
    ds_read_b128 v[96:99], v120 offset:40960
    v_mfma_f32_32x32x16_bf16 v[48:63], v[100:103], v[20:23], v[48:63]
    ds_read_b128 v[100:103], v120 offset:41984
    s_nop 4
    s_waitcnt lgkmcnt(3)
    v_smfmac_f32_32x32x32_bf16 v[64:79], v[104:107], v[32:39], v31
    s_nop 0
    s_waitcnt lgkmcnt(2)
    v_smfmac_f32_32x32x32_bf16 v[64:79], v[108:111], v[40:47], v31
    s_setprio 0
    v_exp_f32 v48, v48
    s_setprio 1
    v_exp_f32 v49, v49
    v_exp_f32 v50, v50
    v_exp_f32 v51, v51
    v_exp_f32 v52, v52
    v_exp_f32 v53, v53
    v_exp_f32 v54, v54
    v_exp_f32 v55, v55
    v_exp_f32 v56, v56
    v_exp_f32 v57, v57
    v_exp_f32 v58, v58
    v_exp_f32 v59, v59
    v_exp_f32 v60, v60
    v_exp_f32 v61, v61
    v_exp_f32 v62, v62
    v_exp_f32 v63, v63
    s_setprio 2
    s_waitcnt lgkmcnt(1)
    v_mfma_f32_32x32x16_bf16 v[32:47], v[96:99], v[8:11], 0
    s_waitcnt lgkmcnt(0)
    v_mfma_f32_32x32x16_bf16 v[32:47], v[100:103], v[12:15], v[32:47]
    s_nop 5
    v_smfmac_f32_32x32x32_bf16 v[80:95], v[104:107], v[48:55], v31
    ds_read_b128 v[24:27], v120 offset:43008
    s_nop 0
    v_smfmac_f32_32x32x32_bf16 v[80:95], v[108:111], v[56:63], v31
    ds_read_b128 v[112:115], v120 offset:44032
    s_setprio 0
    v_exp_f32 v32, v32
    s_setprio 1
    v_exp_f32 v33, v33
    v_exp_f32 v34, v34
    v_exp_f32 v35, v35
    v_exp_f32 v36, v36
    v_exp_f32 v37, v37
    v_exp_f32 v38, v38
    v_exp_f32 v39, v39
    v_exp_f32 v40, v40
    v_exp_f32 v41, v41
    v_exp_f32 v42, v42
    v_exp_f32 v43, v43
    v_exp_f32 v44, v44
    v_exp_f32 v45, v45
    v_exp_f32 v46, v46
    v_exp_f32 v47, v47
    s_setprio 2
    v_mfma_f32_32x32x16_bf16 v[48:63], v[96:99], v[16:19], 0
    ds_read_b128 v[96:99], v120 offset:45056
    v_mfma_f32_32x32x16_bf16 v[48:63], v[100:103], v[20:23], v[48:63]
    ds_read_b128 v[100:103], v120 offset:46080
    s_nop 3
    s_waitcnt lgkmcnt(3)
    v_smfmac_f32_32x32x32_bf16 v[64:79], v[24:27], v[32:39], v31
    ds_read_b128 v[104:107], v120 offset:47104
    s_waitcnt lgkmcnt(3)
    v_smfmac_f32_32x32x32_bf16 v[64:79], v[112:115], v[40:47], v31
    ds_read_b128 v[108:111], v120 offset:48128
    s_setprio 0
    v_exp_f32 v48, v48
    s_setprio 1
    v_exp_f32 v49, v49
    v_exp_f32 v50, v50
    v_exp_f32 v51, v51
    v_exp_f32 v52, v52
    v_exp_f32 v53, v53
    v_exp_f32 v54, v54
    v_exp_f32 v55, v55
    v_exp_f32 v56, v56
    v_exp_f32 v57, v57
    v_exp_f32 v58, v58
    v_exp_f32 v59, v59
    v_exp_f32 v60, v60
    v_exp_f32 v61, v61
    v_exp_f32 v62, v62
    v_exp_f32 v63, v63
    s_setprio 2
    s_waitcnt lgkmcnt(3)
    v_mfma_f32_32x32x16_bf16 v[32:47], v[96:99], v[16:19], 0
    s_waitcnt vmcnt(0)
    v_cmp_ne_u64 vcc, v[4:5], v[126:127]
    s_cbranch_vccnz Lpois
Lpois_ret:
    s_waitcnt lgkmcnt(2)
    v_mfma_f32_32x32x16_bf16 v[32:47], v[100:103], v[20:23], v[32:47]
    s_nop 5
    v_smfmac_f32_32x32x32_bf16 v[80:95], v[24:27], v[48:55], v31
    s_nop 2
    v_smfmac_f32_32x32x32_bf16 v[80:95], v[112:115], v[56:63], v31
    s_setprio 0
    v_exp_f32 v32, v32
    s_setprio 1
    v_exp_f32 v33, v33
    v_exp_f32 v34, v34
    v_exp_f32 v35, v35
    v_exp_f32 v36, v36
    v_exp_f32 v37, v37
    v_exp_f32 v38, v38
    v_exp_f32 v39, v39
    v_exp_f32 v40, v40
    v_exp_f32 v41, v41
    v_exp_f32 v42, v42
    v_exp_f32 v43, v43
    v_exp_f32 v44, v44
    v_exp_f32 v45, v45
    v_exp_f32 v46, v46
    v_exp_f32 v47, v47
    s_setprio 2
    s_waitcnt lgkmcnt(1)
    v_smfmac_f32_32x32x32_bf16 v[80:95], v[104:107], v[32:39], v31
    s_waitcnt lgkmcnt(0)
    v_smfmac_f32_32x32x32_bf16 v[80:95], v[108:111], v[40:47], v31
    buffer_load_dword v4, v3, s[12:15], s46 offen offset:2044 sc1
    s_nop 4
    v_mfma_f32_32x32x16_bf16 v[48:63], v[96:99], v[8:11], 0
    s_nop 4
    ds_write_b128 v116, v[80:83] offset:0
    v_mfma_f32_32x32x16_bf16 v[48:63], v[100:103], v[12:15], v[48:63]
    ds_write_b128 v116, v[84:87] offset:1024
    ds_write_b128 v116, v[88:91] offset:2048
    ds_write_b128 v116, v[92:95] offset:3072
    s_setprio 0
    s_nop 5
    s_cmp_lt_u32 s56, 4
    s_cbranch_scc1 Lbar_63
    s_waitcnt lgkmcnt(0)
    s_barrier
Lbar_63:
    v_exp_f32 v48, v48
    s_setprio 1
    v_exp_f32 v49, v49
    v_exp_f32 v50, v50
    v_exp_f32 v51, v51
    v_exp_f32 v52, v52
    v_exp_f32 v53, v53
    v_exp_f32 v54, v54
    v_exp_f32 v55, v55
    v_exp_f32 v56, v56
    v_exp_f32 v57, v57
    v_exp_f32 v58, v58
    v_exp_f32 v59, v59
    v_exp_f32 v60, v60
    v_exp_f32 v61, v61
    v_exp_f32 v62, v62
    v_exp_f32 v63, v63
    s_cbranch_scc0 Lbarl_64
    s_waitcnt lgkmcnt(0)
    s_barrier
Lbarl_64:
    s_setprio 2
    ds_read_b128 v[32:35], v117 offset:0
    ds_read_b128 v[36:39], v117 offset:1024
    ds_read_b128 v[40:43], v117 offset:2048
    ds_read_b128 v[44:47], v117 offset:3072
    v_smfmac_f32_32x32x32_bf16 v[64:79], v[104:107], v[48:55], v31
    v_smfmac_f32_32x32x32_bf16 v[64:79], v[108:111], v[56:63], v31
    v_mov_b32 v112, 0
    v_mov_b32 v113, 0
    v_mov_b32 v114, 0x71800000
    v_mov_b32 v115, 0x21800000
    s_waitcnt lgkmcnt(0)
    s_nop 6
    v_pk_add_f32 v[64:65], v[64:65], v[32:33]
    v_pk_add_f32 v[66:67], v[66:67], v[34:35]
    v_pk_add_f32 v[68:69], v[68:69], v[36:37]
    v_pk_add_f32 v[70:71], v[70:71], v[38:39]
    v_pk_add_f32 v[72:73], v[72:73], v[40:41]
    v_pk_add_f32 v[74:75], v[74:75], v[42:43]
    v_pk_add_f32 v[76:77], v[76:77], v[44:45]
    v_pk_add_f32 v[78:79], v[78:79], v[46:47]
    v_pk_fma_f32 v[112:113], v[64:65], 0, v[112:113]
    v_pk_fma_f32 v[112:113], v[66:67], 0, v[112:113]
    v_pk_fma_f32 v[112:113], v[68:69], 0, v[112:113]
    v_pk_fma_f32 v[112:113], v[70:71], 0, v[112:113]
    v_pk_fma_f32 v[112:113], v[72:73], 0, v[112:113]
    v_pk_fma_f32 v[112:113], v[74:75], 0, v[112:113]
    v_pk_fma_f32 v[112:113], v[76:77], 0, v[112:113]
    v_pk_fma_f32 v[112:113], v[78:79], 0, v[112:113]
    v_cmp_nle_f32 vcc, v76, v114
    v_cmp_nge_f32 s[64:65], v76, v115
    v_cmp_u_f32 s[66:67], v112, v113
    s_or_b64 vcc, vcc, s[64:65]
    s_and_b64 vcc, vcc, s[70:71]
    s_or_b64 vcc, vcc, s[66:67]
    s_cbranch_scc1 Lfallback
Lepi:
    v_rcp_f32 v112, v76
    s_add_u32 s65, s46, 4096
    v_mul_f32 v112, v112, v7
    s_add_u32 s66, s46, 8192
    v_mov_b32 v113, v112
    s_add_u32 s67, s46, 12288
    s_mov_b32 s42, 0xff
    v_permlane32_swap_b32 v112, v113
    s_nop 0
    v_pk_mul_f32 v[64:65], v[64:65], v[112:113] op_sel_hi:[1,0]
    v_pk_mul_f32 v[66:67], v[66:67], v[112:113] op_sel_hi:[1,0]
    v_pk_mul_f32 v[68:69], v[68:69], v[112:113] op_sel_hi:[1,0]
    v_pk_mul_f32 v[70:71], v[70:71], v[112:113] op_sel_hi:[1,0]
    v_pk_mul_f32 v[72:73], v[72:73], v[112:113] op_sel_hi:[1,0]
    v_pk_mul_f32 v[74:75], v[74:75], v[112:113] op_sel_hi:[1,0]
    v_pk_mul_f32 v[76:77], v[76:77], v[112:113] op_sel_hi:[1,0]
    v_pk_mul_f32 v[78:79], v[78:79], v[112:113] op_sel_hi:[1,0]
    v_cvt_pk_bf16_f32 v24, v64, v65
    v_cvt_pk_bf16_f32 v25, v66, v67
    v_cvt_pk_bf16_f32 v26, v68, v69
    v_cvt_pk_bf16_f32 v27, v70, v71
    buffer_store_dwordx4 v[24:27], v1, s[12:15], s43 offen sc1
    v_cvt_pk_bf16_f32 v28, v72, v73
    v_cvt_pk_bf16_f32 v29, v74, v75
    v_cvt_pk_bf16_f32 v30, v76, v77
    v_cvt_pk_bf16_f32 v31, v78, v79
    v_cndmask_b32 v30, v30, 0, s[70:71]
    v_cndmask_b32 v31, v31, 0, s[70:71]
    s_cmp_eq_u32 s3, 7
    buffer_store_dwordx4 v[28:31], v1, s[12:15], s43 offen offset:1024 sc1
    s_cbranch_scc1 Lend
    s_waitcnt vmcnt(2)
    v_cmp_ne_u32 s[74:75], -1, v4
    s_barrier
    s_and_b32 s49, s74, s42
    s_bitcmp0_b32 s49, 0
    s_cbranch_scc1 Loia_0
    buffer_load_dwordx4 v[64:67], v1, s[12:15], s46 offen offset:0 sc1
    buffer_load_dwordx4 v[68:71], v1, s[12:15], s46 offen offset:1024 sc1
Loia_0:
    s_bitcmp0_b32 s49, 1
    s_cbranch_scc1 Loia_1
    buffer_load_dwordx4 v[72:75], v1, s[12:15], s46 offen offset:2048 sc1
    buffer_load_dwordx4 v[76:79], v1, s[12:15], s46 offen offset:3072 sc1
Loia_1:
    s_bitcmp0_b32 s49, 2
    s_cbranch_scc1 Loia_2
    buffer_load_dwordx4 v[80:83], v1, s[12:15], s65 offen offset:0 sc1
    buffer_load_dwordx4 v[84:87], v1, s[12:15], s65 offen offset:1024 sc1
Loia_2:
    s_bitcmp0_b32 s49, 3
    s_cbranch_scc1 Loia_3
    buffer_load_dwordx4 v[88:91], v1, s[12:15], s65 offen offset:2048 sc1
    buffer_load_dwordx4 v[92:95], v1, s[12:15], s65 offen offset:3072 sc1
Loia_3:
    s_bitcmp0_b32 s49, 4
    s_cbranch_scc1 Loia_4
    buffer_load_dwordx4 v[96:99], v1, s[12:15], s66 offen offset:0 sc1
    buffer_load_dwordx4 v[100:103], v1, s[12:15], s66 offen offset:1024 sc1
Loia_4:
    s_bitcmp0_b32 s49, 5
    s_cbranch_scc1 Loia_5
    buffer_load_dwordx4 v[104:107], v1, s[12:15], s66 offen offset:2048 sc1
    buffer_load_dwordx4 v[108:111], v1, s[12:15], s66 offen offset:3072 sc1
Loia_5:
    s_bitcmp0_b32 s49, 6
    s_cbranch_scc1 Loia_6
    buffer_load_dwordx4 v[112:115], v1, s[12:15], s67 offen offset:0 sc1
    buffer_load_dwordx4 v[116:119], v1, s[12:15], s67 offen offset:1024 sc1
Loia_6:
    s_bitcmp0_b32 s49, 7
    s_cbranch_scc1 Loia_7
    buffer_load_dwordx4 v[120:123], v1, s[12:15], s67 offen offset:2048 sc1
    buffer_load_dwordx4 v[124:127], v1, s[12:15], s67 offen offset:3072 sc1
Loia_7:
    buffer_load_dword v4, v3, s[12:15], s46 offen offset:2044 sc1
    s_mov_b64 s[50:51], -1
    s_mov_b32 s78, 0x4000
    v_mov_b64 v[32:33], 0
    v_mov_b64 v[34:35], 0
    v_mov_b64 v[36:37], 0
    v_mov_b64 v[38:39], 0
    v_mov_b64 v[40:41], 0
    v_mov_b64 v[42:43], 0
    v_mov_b64 v[44:45], 0
    v_mov_b64 v[46:47], 0
    v_mov_b64 v[48:49], 0
    v_mov_b64 v[50:51], 0
    v_mov_b64 v[52:53], 0
    v_mov_b64 v[54:55], 0
    v_mov_b64 v[56:57], 0
    v_mov_b64 v[58:59], 0
    v_mov_b64 v[60:61], 0
    v_mov_b64 v[62:63], 0
    v_and_b32 v11, 31, v2
    v_lshrrev_b32 v19, 5, v2
    v_and_b32 v10, 7, v2
    v_xor_b32 v19, v19, v10
    v_lshlrev_b32 v19, 4, v19
    v_lshl_add_u32 v11, v11, 8, v19
    s_lshl_b32 s64, s56, 13
    s_add_u32 s64, s64, 65536
    v_add_u32 v12, s64, v11
    v_xor_b32 v13, 32, v12
    v_xor_b32 v14, 64, v12
    v_xor_b32 v15, 96, v12
    v_lshrrev_b32 v11, 3, v2
    v_lshlrev_b32 v19, 1, v10
    v_xor_b32 v19, v19, v11
    v_lshlrev_b32 v19, 4, v19
    v_lshl_add_u32 v19, v11, 8, v19
    s_and_b32 s64, s56, 3
    s_lshl_b32 s64, s64, 11
    s_lshr_b32 s68, s56, 2
    s_lshl_b32 s68, s68, 15
    s_add_u32 s64, s64, s68
    s_add_u32 s64, s64, 65536
    v_add_u32 v16, s64, v19
    v_xor_b32 v17, 16, v16
    v_mul_u32_u24 v11, 896, v11
    v_lshl_add_u32 v18, v10, 4, v11
    s_lshl_b32 s64, s36, 3
    s_add_u32 s64, s64, s56
    s_mul_i32 s64, s64, 7168
    s_lshl_b32 s68, s3, 7
    s_add_u32 s48, s64, s68
Leval:
    s_bitcmp0_b32 s49, 0
    s_cbranch_scc1 Lev_0
    s_lshr_b32 s64, s49, 1
    s_bcnt1_i32_b32 s64, s64
    s_waitcnt vmcnt(13)
    s_cmp_ge_u32 s64, 6
    s_cbranch_scc1 Lew_0
    s_waitcnt vmcnt(9)
    s_cmp_ge_u32 s64, 4
    s_cbranch_scc1 Lew_0
    s_waitcnt vmcnt(5)
    s_cmp_ge_u32 s64, 2
    s_cbranch_scc1 Lew_0
    s_waitcnt vmcnt(3)
    s_cmp_ge_u32 s64, 1
    s_cbranch_scc1 Lew_0
    s_waitcnt vmcnt(1)
Lew_0:
    v_max3_u32 v8, v64, v65, v66
    v_max3_u32 v9, v67, v68, v69
    v_max3_u32 v8, v8, v70, v71
    v_max_u32 v8, v8, v9
    v_cmp_eq_u32 vcc, -1, v8
    s_and_b64 vcc, vcc, s[50:51]
    s_cbranch_scc1 Lev_0
    v_mfma_f32_32x32x16_bf16 v[32:47], v[128:131], v[64:67], v[32:47]
    v_mfma_f32_32x32x16_bf16 v[48:63], v[132:135], v[64:67], v[48:63]
    v_mfma_f32_32x32x16_bf16 v[32:47], v[136:139], v[68:71], v[32:47]
    v_mfma_f32_32x32x16_bf16 v[48:63], v[140:143], v[68:71], v[48:63]
    s_bitset0_b32 s42, 0
Lev_0:
    s_bitcmp0_b32 s49, 1
    s_cbranch_scc1 Lev_1
    s_lshr_b32 s64, s49, 2
    s_bcnt1_i32_b32 s64, s64
    s_waitcnt vmcnt(13)
    s_cmp_ge_u32 s64, 6
    s_cbranch_scc1 Lew_1
    s_waitcnt vmcnt(9)
    s_cmp_ge_u32 s64, 4
    s_cbranch_scc1 Lew_1
    s_waitcnt vmcnt(5)
    s_cmp_ge_u32 s64, 2
    s_cbranch_scc1 Lew_1
    s_waitcnt vmcnt(3)
    s_cmp_ge_u32 s64, 1
    s_cbranch_scc1 Lew_1
    s_waitcnt vmcnt(1)
Lew_1:
    v_max3_u32 v8, v72, v73, v74
    v_max3_u32 v9, v75, v76, v77
    v_max3_u32 v8, v8, v78, v79
    v_max_u32 v8, v8, v9
    v_cmp_eq_u32 vcc, -1, v8
    s_and_b64 vcc, vcc, s[50:51]
    s_cbranch_scc1 Lev_1
    v_mfma_f32_32x32x16_bf16 v[32:47], v[144:147], v[72:75], v[32:47]
    v_mfma_f32_32x32x16_bf16 v[48:63], v[148:151], v[72:75], v[48:63]
    v_mfma_f32_32x32x16_bf16 v[32:47], v[152:155], v[76:79], v[32:47]
    v_mfma_f32_32x32x16_bf16 v[48:63], v[156:159], v[76:79], v[48:63]
    s_bitset0_b32 s42, 1
Lev_1:
    s_bitcmp0_b32 s49, 2
    s_cbranch_scc1 Lev_2
    s_lshr_b32 s64, s49, 3
    s_bcnt1_i32_b32 s64, s64
    s_waitcnt vmcnt(9)
    s_cmp_ge_u32 s64, 4
    s_cbranch_scc1 Lew_2
    s_waitcnt vmcnt(5)
    s_cmp_ge_u32 s64, 2
    s_cbranch_scc1 Lew_2
    s_waitcnt vmcnt(3)
    s_cmp_ge_u32 s64, 1
    s_cbranch_scc1 Lew_2
    s_waitcnt vmcnt(1)
Lew_2:
    v_max3_u32 v8, v80, v81, v82
    v_max3_u32 v9, v83, v84, v85
    v_max3_u32 v8, v8, v86, v87
    v_max_u32 v8, v8, v9
    v_cmp_eq_u32 vcc, -1, v8
    s_and_b64 vcc, vcc, s[50:51]
    s_cbranch_scc1 Lev_2
    v_mfma_f32_32x32x16_bf16 v[32:47], v[160:163], v[80:83], v[32:47]
    v_mfma_f32_32x32x16_bf16 v[48:63], v[164:167], v[80:83], v[48:63]
    v_mfma_f32_32x32x16_bf16 v[32:47], v[168:171], v[84:87], v[32:47]
    v_mfma_f32_32x32x16_bf16 v[48:63], v[172:175], v[84:87], v[48:63]
    s_bitset0_b32 s42, 2
Lev_2:
    s_bitcmp0_b32 s49, 3
    s_cbranch_scc1 Lev_3
    s_lshr_b32 s64, s49, 4
    s_bcnt1_i32_b32 s64, s64
    s_waitcnt vmcnt(9)
    s_cmp_ge_u32 s64, 4
    s_cbranch_scc1 Lew_3
    s_waitcnt vmcnt(5)
    s_cmp_ge_u32 s64, 2
    s_cbranch_scc1 Lew_3
    s_waitcnt vmcnt(3)
    s_cmp_ge_u32 s64, 1
    s_cbranch_scc1 Lew_3
    s_waitcnt vmcnt(1)
Lew_3:
    v_max3_u32 v8, v88, v89, v90
    v_max3_u32 v9, v91, v92, v93
    v_max3_u32 v8, v8, v94, v95
    v_max_u32 v8, v8, v9
    v_cmp_eq_u32 vcc, -1, v8
    s_and_b64 vcc, vcc, s[50:51]
    s_cbranch_scc1 Lev_3
    v_mfma_f32_32x32x16_bf16 v[32:47], v[176:179], v[88:91], v[32:47]
    v_mfma_f32_32x32x16_bf16 v[48:63], v[180:183], v[88:91], v[48:63]
    v_mfma_f32_32x32x16_bf16 v[32:47], v[184:187], v[92:95], v[32:47]
    v_mfma_f32_32x32x16_bf16 v[48:63], v[188:191], v[92:95], v[48:63]
    s_bitset0_b32 s42, 3
Lev_3:
    s_bitcmp0_b32 s49, 4
    s_cbranch_scc1 Lev_4
    s_lshr_b32 s64, s49, 5
    s_bcnt1_i32_b32 s64, s64
    s_waitcnt vmcnt(5)
    s_cmp_ge_u32 s64, 2
    s_cbranch_scc1 Lew_4
    s_waitcnt vmcnt(3)
    s_cmp_ge_u32 s64, 1
    s_cbranch_scc1 Lew_4
    s_waitcnt vmcnt(1)
Lew_4:
    v_max3_u32 v8, v96, v97, v98
    v_max3_u32 v9, v99, v100, v101
    v_max3_u32 v8, v8, v102, v103
    v_max_u32 v8, v8, v9
    v_cmp_eq_u32 vcc, -1, v8
    s_and_b64 vcc, vcc, s[50:51]
    s_cbranch_scc1 Lev_4
    v_mfma_f32_32x32x16_bf16 v[32:47], v[192:195], v[96:99], v[32:47]
    v_mfma_f32_32x32x16_bf16 v[48:63], v[196:199], v[96:99], v[48:63]
    v_mfma_f32_32x32x16_bf16 v[32:47], v[200:203], v[100:103], v[32:47]
    v_mfma_f32_32x32x16_bf16 v[48:63], v[204:207], v[100:103], v[48:63]
    s_bitset0_b32 s42, 4
Lev_4:
    s_bitcmp0_b32 s49, 5
    s_cbranch_scc1 Lev_5
    s_lshr_b32 s64, s49, 6
    s_bcnt1_i32_b32 s64, s64
    s_waitcnt vmcnt(5)
    s_cmp_ge_u32 s64, 2
    s_cbranch_scc1 Lew_5
    s_waitcnt vmcnt(3)
    s_cmp_ge_u32 s64, 1
    s_cbranch_scc1 Lew_5
    s_waitcnt vmcnt(1)
Lew_5:
    v_max3_u32 v8, v104, v105, v106
    v_max3_u32 v9, v107, v108, v109
    v_max3_u32 v8, v8, v110, v111
    v_max_u32 v8, v8, v9
    v_cmp_eq_u32 vcc, -1, v8
    s_and_b64 vcc, vcc, s[50:51]
    s_cbranch_scc1 Lev_5
    v_mfma_f32_32x32x16_bf16 v[32:47], v[208:211], v[104:107], v[32:47]
    v_mfma_f32_32x32x16_bf16 v[48:63], v[212:215], v[104:107], v[48:63]
    v_mfma_f32_32x32x16_bf16 v[32:47], v[216:219], v[108:111], v[32:47]
    v_mfma_f32_32x32x16_bf16 v[48:63], v[220:223], v[108:111], v[48:63]
    s_bitset0_b32 s42, 5
Lev_5:
    s_bitcmp0_b32 s49, 6
    s_cbranch_scc1 Lev_6
    s_lshr_b32 s64, s49, 7
    s_bcnt1_i32_b32 s64, s64
    s_waitcnt vmcnt(3)
    s_cmp_ge_u32 s64, 1
    s_cbranch_scc1 Lew_6
    s_waitcnt vmcnt(1)
Lew_6:
    v_max3_u32 v8, v112, v113, v114
    v_max3_u32 v9, v115, v116, v117
    v_max3_u32 v8, v8, v118, v119
    v_max_u32 v8, v8, v9
    v_cmp_eq_u32 vcc, -1, v8
    s_and_b64 vcc, vcc, s[50:51]
    s_cbranch_scc1 Lev_6
    v_mfma_f32_32x32x16_bf16 v[32:47], v[224:227], v[112:115], v[32:47]
    v_mfma_f32_32x32x16_bf16 v[48:63], v[228:231], v[112:115], v[48:63]
    v_mfma_f32_32x32x16_bf16 v[32:47], v[232:235], v[116:119], v[32:47]
    v_mfma_f32_32x32x16_bf16 v[48:63], v[236:239], v[116:119], v[48:63]
    s_bitset0_b32 s42, 6
Lev_6:
    s_bitcmp0_b32 s49, 7
    s_cbranch_scc1 Lev_7
    s_waitcnt vmcnt(1)
Lew_7:
    v_max3_u32 v8, v120, v121, v122
    v_max3_u32 v9, v123, v124, v125
    v_max3_u32 v8, v8, v126, v127
    v_max_u32 v8, v8, v9
    v_cmp_eq_u32 vcc, -1, v8
    s_and_b64 vcc, vcc, s[50:51]
    s_cbranch_scc1 Lev_7
    v_mfma_f32_32x32x16_bf16 v[32:47], v[240:243], v[120:123], v[32:47]
    v_mfma_f32_32x32x16_bf16 v[48:63], v[244:247], v[120:123], v[48:63]
    v_mfma_f32_32x32x16_bf16 v[32:47], v[248:251], v[124:127], v[32:47]
    v_mfma_f32_32x32x16_bf16 v[48:63], v[252:255], v[124:127], v[48:63]
    s_bitset0_b32 s42, 7
Lev_7:
    s_cmp_lg_u32 s42, 0
    s_cbranch_scc1 Loround
    s_nop 10
    ds_write_b128 v12, v[32:35] offset:0
    ds_write_b128 v13, v[36:39] offset:0
    ds_write_b128 v14, v[40:43] offset:0
    ds_write_b128 v15, v[44:47] offset:0
    ds_write_b128 v12, v[48:51] offset:128
    ds_write_b128 v13, v[52:55] offset:128
    ds_write_b128 v14, v[56:59] offset:128
    ds_write_b128 v15, v[60:63] offset:128
    s_waitcnt lgkmcnt(0)
    s_barrier
    ds_read_b128 v[64:67], v16 offset:0
    ds_read_b128 v[68:71], v17 offset:0
    ds_read_b128 v[72:75], v16 offset:8192
    ds_read_b128 v[76:79], v17 offset:8192
    ds_read_b128 v[80:83], v16 offset:16384
    ds_read_b128 v[84:87], v17 offset:16384
    ds_read_b128 v[88:91], v16 offset:24576
    ds_read_b128 v[92:95], v17 offset:24576
    s_waitcnt lgkmcnt(4)
    v_pk_add_f32 v[64:65], v[64:65], v[72:73]
    v_pk_add_f32 v[66:67], v[66:67], v[74:75]
    v_pk_add_f32 v[68:69], v[68:69], v[76:77]
    v_pk_add_f32 v[70:71], v[70:71], v[78:79]
    s_waitcnt lgkmcnt(2)
    v_pk_add_f32 v[64:65], v[64:65], v[80:81]
    v_pk_add_f32 v[66:67], v[66:67], v[82:83]
    v_pk_add_f32 v[68:69], v[68:69], v[84:85]
    v_pk_add_f32 v[70:71], v[70:71], v[86:87]
    s_waitcnt lgkmcnt(0)
    v_pk_add_f32 v[64:65], v[64:65], v[88:89]
    v_pk_add_f32 v[66:67], v[66:67], v[90:91]
    v_pk_add_f32 v[68:69], v[68:69], v[92:93]
    v_pk_add_f32 v[70:71], v[70:71], v[94:95]
    v_cvt_pk_bf16_f32 v24, v64, v65
    v_cvt_pk_bf16_f32 v25, v66, v67
    v_cvt_pk_bf16_f32 v26, v68, v69
    v_cvt_pk_bf16_f32 v27, v70, v71
    buffer_store_dwordx4 v[24:27], v18, s[28:31], s48 offen
Lend:
    s_endpgm
Lnonce_wait:
    s_mov_b32 s78, 0x4000
Lnonce_l:
    buffer_load_dwordx2 v[126:127], v6, s[32:35], 0 offen sc1
    s_waitcnt vmcnt(0)
    v_cmp_eq_u64 vcc, 0, v[126:127]
    s_cbranch_vccz Lnonce_ok
    s_sub_u32 s78, s78, 1
    s_cbranch_scc0 Lnonce_l
    s_branch Lnonce_ok
Llp_2:
    s_mov_b32 s78, 0x100
Llp_2_l:
    ds_read_b128 v[112:115], v117 offset:16384
    s_waitcnt lgkmcnt(0)
    v_max3_u32 v112, v112, v113, v114
    v_max_u32 v112, v112, v115
    v_cmp_eq_u32 vcc, -1, v112
    s_cbranch_vccz Llp_2_ret
    s_sub_u32 s78, s78, 1
    s_cbranch_scc0 Llp_2_l
    s_waitcnt vmcnt(0)
    s_branch Llp_2_ret
Llp_3:
    s_mov_b32 s78, 0x100
Llp_3_l:
    ds_read_b128 v[112:115], v117 offset:24576
    s_waitcnt lgkmcnt(0)
    v_max3_u32 v112, v112, v113, v114
    v_max_u32 v112, v112, v115
    v_cmp_eq_u32 vcc, -1, v112
    s_cbranch_vccz Llp_3_ret
    s_sub_u32 s78, s78, 1
    s_cbranch_scc0 Llp_3_l
    s_waitcnt vmcnt(0)
    s_branch Llp_3_ret
Lgo_1:
    s_ff1_i32_b32 s64, s64
    s_mov_b32 m0, s52
    s_add_u32 s52, s52, 32768
    s_bitset0_b32 s42, s64
    s_lshl_b32 s64, s64, 15
    s_add_u32 s64, s64, s68
    s_and_b32 s64, s64, 0x3ffff
    s_or_b32 s48, s64, s47
    buffer_load_dwordx4 v1, s[12:15], s48 offen offset:0 sc1 lds
    buffer_load_dwordx4 v1, s[12:15], s48 offen offset:1024 sc1 lds
    buffer_load_dwordx4 v1, s[12:15], s48 offen offset:2048 sc1 lds
    buffer_load_dwordx4 v1, s[12:15], s48 offen offset:3072 sc1 lds
    s_cmp_ge_u32 s52, 98304
    s_cbranch_scc1 Lchk_1
    s_and_b32 s64, s74, s42
    s_cbranch_scc1 Lgo_1
    s_branch Lgo_1_ret
Lgo_2:
    s_ff1_i32_b32 s64, s64
    s_mov_b32 m0, s52
    s_add_u32 s52, s52, 32768
    s_bitset0_b32 s42, s64
    s_lshl_b32 s64, s64, 15
    s_add_u32 s64, s64, s68
    s_and_b32 s64, s64, 0x3ffff
    s_or_b32 s48, s64, s47
    buffer_load_dwordx4 v1, s[12:15], s48 offen offset:0 sc1 lds
    buffer_load_dwordx4 v1, s[12:15], s48 offen offset:1024 sc1 lds
    buffer_load_dwordx4 v1, s[12:15], s48 offen offset:2048 sc1 lds
    buffer_load_dwordx4 v1, s[12:15], s48 offen offset:3072 sc1 lds
    s_cmp_ge_u32 s52, 98304
    s_cbranch_scc1 Lchk_2
    s_and_b32 s64, s74, s42
    s_cbranch_scc1 Lgo_2
    s_branch Lgo_2_ret
Lgo_3:
    s_ff1_i32_b32 s64, s64
    s_mov_b32 m0, s52
    s_add_u32 s52, s52, 32768
    s_bitset0_b32 s42, s64
    s_lshl_b32 s64, s64, 15
    s_add_u32 s64, s64, s68
    s_and_b32 s64, s64, 0x3ffff
    s_or_b32 s48, s64, s47
    buffer_load_dwordx4 v1, s[12:15], s48 offen offset:0 sc1 lds
    buffer_load_dwordx4 v1, s[12:15], s48 offen offset:1024 sc1 lds
    buffer_load_dwordx4 v1, s[12:15], s48 offen offset:2048 sc1 lds
    buffer_load_dwordx4 v1, s[12:15], s48 offen offset:3072 sc1 lds
    s_cmp_ge_u32 s52, 98304
    s_cbranch_scc1 Lchk_3
    s_and_b32 s64, s74, s42
    s_cbranch_scc1 Lgo_3
    s_branch Lgo_3_ret
Lgo_4:
    s_ff1_i32_b32 s64, s64
    s_mov_b32 m0, s52
    s_add_u32 s52, s52, 32768
    s_bitset0_b32 s42, s64
    s_lshl_b32 s64, s64, 15
    s_add_u32 s64, s64, s68
    s_and_b32 s64, s64, 0x3ffff
    s_or_b32 s48, s64, s47
    buffer_load_dwordx4 v1, s[12:15], s48 offen offset:0 sc1 lds
    buffer_load_dwordx4 v1, s[12:15], s48 offen offset:1024 sc1 lds
    buffer_load_dwordx4 v1, s[12:15], s48 offen offset:2048 sc1 lds
    buffer_load_dwordx4 v1, s[12:15], s48 offen offset:3072 sc1 lds
    s_cmp_ge_u32 s52, 98304
    s_cbranch_scc1 Lchk_4
    s_and_b32 s64, s74, s42
    s_cbranch_scc1 Lgo_4
    s_branch Lgo_4_ret
Lgo_5:
    s_ff1_i32_b32 s64, s64
    s_mov_b32 m0, s52
    s_add_u32 s52, s52, 32768
    s_bitset0_b32 s42, s64
    s_lshl_b32 s64, s64, 15
    s_add_u32 s64, s64, s68
    s_and_b32 s64, s64, 0x3ffff
    s_or_b32 s48, s64, s47
    buffer_load_dwordx4 v1, s[12:15], s48 offen offset:0 sc1 lds
    buffer_load_dwordx4 v1, s[12:15], s48 offen offset:1024 sc1 lds
    buffer_load_dwordx4 v1, s[12:15], s48 offen offset:2048 sc1 lds
    buffer_load_dwordx4 v1, s[12:15], s48 offen offset:3072 sc1 lds
    s_cmp_ge_u32 s52, 98304
    s_cbranch_scc1 Lchk_5
    s_and_b32 s64, s74, s42
    s_cbranch_scc1 Lgo_5
    s_branch Lgo_5_ret
Lgo_6:
    s_ff1_i32_b32 s64, s64
    s_mov_b32 m0, s52
    s_add_u32 s52, s52, 32768
    s_bitset0_b32 s42, s64
    s_lshl_b32 s64, s64, 15
    s_add_u32 s64, s64, s68
    s_and_b32 s64, s64, 0x3ffff
    s_or_b32 s48, s64, s47
    buffer_load_dwordx4 v1, s[12:15], s48 offen offset:0 sc1 lds
    buffer_load_dwordx4 v1, s[12:15], s48 offen offset:1024 sc1 lds
    buffer_load_dwordx4 v1, s[12:15], s48 offen offset:2048 sc1 lds
    buffer_load_dwordx4 v1, s[12:15], s48 offen offset:3072 sc1 lds
    s_cmp_ge_u32 s52, 98304
    s_cbranch_scc1 Lchk_6
    s_and_b32 s64, s74, s42
    s_cbranch_scc1 Lgo_6
    s_branch Lgo_6_ret
Lspin0:
    s_mov_b32 s78, 0x4000
Lspin0_l:
    s_waitcnt vmcnt(0)
    v_cmp_eq_u64 s[74:75], v[4:5], v[126:127]
    s_and_b32 s64, s74, s42
    s_cbranch_scc1 Lspin0_go
    buffer_load_dwordx2 v[4:5], v123, s[12:15], s38 offen sc1
    s_sub_u32 s78, s78, 1
    s_cbranch_scc0 Lspin0_l
    s_mov_b32 s64, s42
Lspin0_go:
    s_ff1_i32_b32 s64, s64
    s_mov_b32 m0, s52
    s_add_u32 s52, s52, 32768
    s_bitset0_b32 s42, s64
    s_lshl_b32 s64, s64, 15
    s_add_u32 s64, s64, s68
    s_and_b32 s64, s64, 0x3ffff
    s_or_b32 s48, s64, s47
    buffer_load_dwordx4 v1, s[12:15], s48 offen offset:0 sc1 lds
    buffer_load_dwordx4 v1, s[12:15], s48 offen offset:1024 sc1 lds
    buffer_load_dwordx4 v1, s[12:15], s48 offen offset:2048 sc1 lds
    buffer_load_dwordx4 v1, s[12:15], s48 offen offset:3072 sc1 lds
    s_cmp_ge_u32 s52, 98304
    s_cbranch_scc1 Lspin0_ret
    s_and_b32 s64, s74, s42
    s_cbranch_scc1 Lspin0_go
    s_branch Lspin0
Lslow_0:
    s_mov_b32 s78, 0x4000
Lslow_0_l:
    buffer_load_dwordx2 v[4:5], v123, s[12:15], s38 offen sc1
    s_waitcnt vmcnt(0)
    v_cmp_eq_u64 s[74:75], v[4:5], v[126:127]
    s_and_b32 s64, s74, s42
    s_cbranch_scc1 Lslow_0_ret
    s_sub_u32 s78, s78, 1
    s_cbranch_scc0 Lslow_0_l
    s_mov_b32 s64, s42
    s_branch Lslow_0_ret
Lslow_1:
    s_mov_b32 s78, 0x4000
Lslow_1_l:
    buffer_load_dwordx2 v[4:5], v123, s[12:15], s38 offen sc1
    s_waitcnt vmcnt(0)
    v_cmp_eq_u64 s[74:75], v[4:5], v[126:127]
    s_and_b32 s64, s74, s42
    s_cbranch_scc1 Lslow_1_ret
    s_sub_u32 s78, s78, 1
    s_cbranch_scc0 Lslow_1_l
    s_mov_b32 s64, s42
    s_branch Lslow_1_ret
Lslow_2:
    s_mov_b32 s78, 0x4000
Lslow_2_l:
    buffer_load_dwordx2 v[4:5], v123, s[12:15], s38 offen sc1
    s_waitcnt vmcnt(0)
    v_cmp_eq_u64 s[74:75], v[4:5], v[126:127]
    s_and_b32 s64, s74, s42
    s_cbranch_scc1 Lslow_2_ret
    s_sub_u32 s78, s78, 1
    s_cbranch_scc0 Lslow_2_l
    s_mov_b32 s64, s42
    s_branch Lslow_2_ret
Lslow_3:
    s_mov_b32 s78, 0x4000
Lslow_3_l:
    buffer_load_dwordx2 v[4:5], v123, s[12:15], s38 offen sc1
    s_waitcnt vmcnt(0)
    v_cmp_eq_u64 s[74:75], v[4:5], v[126:127]
    s_and_b32 s64, s74, s42
    s_cbranch_scc1 Lslow_3_ret
    s_sub_u32 s78, s78, 1
    s_cbranch_scc0 Lslow_3_l
    s_mov_b32 s64, s42
    s_branch Lslow_3_ret
Lslow_4:
    s_mov_b32 s78, 0x4000
Lslow_4_l:
    buffer_load_dwordx2 v[4:5], v123, s[12:15], s38 offen sc1
    s_waitcnt vmcnt(0)
    v_cmp_eq_u64 s[74:75], v[4:5], v[126:127]
    s_and_b32 s64, s74, s42
    s_cbranch_scc1 Lslow_4_ret
    s_sub_u32 s78, s78, 1
    s_cbranch_scc0 Lslow_4_l
    s_mov_b32 s64, s42
    s_branch Lslow_4_ret
Lpois:
    s_mov_b32 s78, 0x4000
Lpois_l:
    buffer_load_dwordx2 v[4:5], v122, s[12:15], s45 offen sc1
    s_waitcnt vmcnt(0)
    v_cmp_ne_u64 vcc, v[4:5], v[126:127]
    s_cbranch_vccz Lpois_ret
    s_sub_u32 s78, s78, 1
    s_cbranch_scc0 Lpois_l
    s_branch Lpois_ret
Loround:
    s_waitcnt vmcnt(0)
    v_cmp_ne_u32 s[74:75], -1, v4
    s_sub_u32 s78, s78, 1
    s_cbranch_scc0 Loin
    s_mov_b64 s[50:51], 0
    s_mov_b32 s74, 0xff
Loin:
    s_and_b32 s49, s74, s42
    s_bitcmp0_b32 s49, 0
    s_cbranch_scc1 Loib_0
    buffer_load_dwordx4 v[64:67], v1, s[12:15], s46 offen offset:0 sc1
    buffer_load_dwordx4 v[68:71], v1, s[12:15], s46 offen offset:1024 sc1
Loib_0:
    s_bitcmp0_b32 s49, 1
    s_cbranch_scc1 Loib_1
    buffer_load_dwordx4 v[72:75], v1, s[12:15], s46 offen offset:2048 sc1
    buffer_load_dwordx4 v[76:79], v1, s[12:15], s46 offen offset:3072 sc1
Loib_1:
    s_bitcmp0_b32 s49, 2
    s_cbranch_scc1 Loib_2
    buffer_load_dwordx4 v[80:83], v1, s[12:15], s65 offen offset:0 sc1
    buffer_load_dwordx4 v[84:87], v1, s[12:15], s65 offen offset:1024 sc1
Loib_2:
    s_bitcmp0_b32 s49, 3
    s_cbranch_scc1 Loib_3
    buffer_load_dwordx4 v[88:91], v1, s[12:15], s65 offen offset:2048 sc1
    buffer_load_dwordx4 v[92:95], v1, s[12:15], s65 offen offset:3072 sc1
Loib_3:
    s_bitcmp0_b32 s49, 4
    s_cbranch_scc1 Loib_4
    buffer_load_dwordx4 v[96:99], v1, s[12:15], s66 offen offset:0 sc1
    buffer_load_dwordx4 v[100:103], v1, s[12:15], s66 offen offset:1024 sc1
Loib_4:
    s_bitcmp0_b32 s49, 5
    s_cbranch_scc1 Loib_5
    buffer_load_dwordx4 v[104:107], v1, s[12:15], s66 offen offset:2048 sc1
    buffer_load_dwordx4 v[108:111], v1, s[12:15], s66 offen offset:3072 sc1
Loib_5:
    s_bitcmp0_b32 s49, 6
    s_cbranch_scc1 Loib_6
    buffer_load_dwordx4 v[112:115], v1, s[12:15], s67 offen offset:0 sc1
    buffer_load_dwordx4 v[116:119], v1, s[12:15], s67 offen offset:1024 sc1
Loib_6:
    s_bitcmp0_b32 s49, 7
    s_cbranch_scc1 Loib_7
    buffer_load_dwordx4 v[120:123], v1, s[12:15], s67 offen offset:2048 sc1
    buffer_load_dwordx4 v[124:127], v1, s[12:15], s67 offen offset:3072 sc1
Loib_7:
    buffer_load_dword v4, v3, s[12:15], s46 offen offset:2044 sc1
    s_branch Leval
Lfallback:
    v_cndmask_b32 v14, v14, 0, s[70:71]
    v_mov_b32 v112, 0xff800000
    s_lshl_b32 s64, s57, 18
    s_mov_b32 s65, 64
Lfb1:
    buffer_load_dwordx4 v[96:99], v1, s[12:15], s64 offen sc1
    buffer_load_dwordx4 v[100:103], v1, s[12:15], s64 offen offset:1024 sc1
    s_waitcnt vmcnt(0)
    v_mfma_f32_32x32x16_bf16 v[32:47], v[96:99], v[8:11], 0
    v_mfma_f32_32x32x16_bf16 v[32:47], v[100:103], v[12:15], v[32:47]
    s_nop 11
    v_max3_f32 v112, v112, v32, v33
    v_max3_f32 v112, v112, v34, v35
    v_max3_f32 v112, v112, v36, v37
    v_max3_f32 v112, v112, v38, v39
    v_max3_f32 v112, v112, v40, v41
    v_max3_f32 v112, v112, v42, v43
    v_max3_f32 v112, v112, v44, v45
    v_max3_f32 v112, v112, v46, v47
    s_add_u32 s64, s64, 4096
    s_sub_u32 s65, s65, 1
    s_cmp_lg_u32 s65, 0
    s_cbranch_scc1 Lfb1
    v_mov_b32 v113, v112
    s_nop 1
    v_permlane32_swap_b32 v112, v113
    s_nop 1
    v_max_f32 v112, v112, v113
    v_sub_f32 v48, 0, v112
    v_mov_b32 v64, 0
    v_sub_f32 v49, 0, v112
    v_mov_b32 v65, 0
    v_sub_f32 v50, 0, v112
    v_mov_b32 v66, 0
    v_sub_f32 v51, 0, v112
    v_mov_b32 v67, 0
    v_sub_f32 v52, 0, v112
    v_mov_b32 v68, 0
    v_sub_f32 v53, 0, v112
    v_mov_b32 v69, 0
    v_sub_f32 v54, 0, v112
    v_mov_b32 v70, 0
    v_sub_f32 v55, 0, v112
    v_mov_b32 v71, 0
    v_sub_f32 v56, 0, v112
    v_mov_b32 v72, 0
    v_sub_f32 v57, 0, v112
    v_mov_b32 v73, 0
    v_sub_f32 v58, 0, v112
    v_mov_b32 v74, 0
    v_sub_f32 v59, 0, v112
    v_mov_b32 v75, 0
    v_sub_f32 v60, 0, v112
    v_mov_b32 v76, 0
    v_sub_f32 v61, 0, v112
    v_mov_b32 v77, 0
    v_sub_f32 v62, 0, v112
    v_mov_b32 v78, 0
    v_sub_f32 v63, 0, v112
    v_mov_b32 v79, 0
    s_lshl_b32 s64, s57, 18
    s_mov_b32 s65, 64
Lfb2:
    buffer_load_dwordx4 v[96:99], v1, s[12:15], s64 offen offset:0 sc1
    buffer_load_dwordx4 v[100:103], v1, s[12:15], s64 offen offset:1024 sc1
    buffer_load_dwordx4 v[104:107], v1, s[12:15], s64 offen offset:2048 sc1
    buffer_load_dwordx4 v[108:111], v1, s[12:15], s64 offen offset:3072 sc1
    s_waitcnt vmcnt(0)
    v_mfma_f32_32x32x16_bf16 v[32:47], v[96:99], v[8:11], v[48:63]
    v_mfma_f32_32x32x16_bf16 v[32:47], v[100:103], v[12:15], v[32:47]
    s_nop 11
    v_exp_f32 v32, v32
    v_exp_f32 v33, v33
    v_exp_f32 v34, v34
    v_exp_f32 v35, v35
    v_exp_f32 v36, v36
    v_exp_f32 v37, v37
    v_exp_f32 v38, v38
    v_exp_f32 v39, v39
    v_exp_f32 v40, v40
    v_exp_f32 v41, v41
    v_exp_f32 v42, v42
    v_exp_f32 v43, v43
    v_exp_f32 v44, v44
    v_exp_f32 v45, v45
    v_exp_f32 v46, v46
    v_exp_f32 v47, v47
    s_nop 1
    v_smfmac_f32_32x32x32_bf16 v[64:79], v[104:107], v[32:39], v31
    v_smfmac_f32_32x32x32_bf16 v[64:79], v[108:111], v[40:47], v31
    s_add_u32 s64, s64, 4096
    s_sub_u32 s65, s65, 1
    s_cmp_lg_u32 s65, 0
    s_cbranch_scc1 Lfb2
    s_nop 11
    s_branch Lepi
    s_endpgm
Lcode_end:
.section .rodata,"a"
.p2align 6
.amdhsa_kernel fused_kernel
  .amdhsa_next_free_vgpr 256
  .amdhsa_next_free_sgpr 102
  .amdhsa_accum_offset 256
  .amdhsa_group_segment_fixed_size 0
  .amdhsa_kernarg_size 80
  .amdhsa_user_sgpr_count 2
  .amdhsa_user_sgpr_kernarg_segment_ptr 1
  .amdhsa_system_sgpr_workgroup_id_x 1
.end_amdhsa_kernel
```
